```python
import torch

def _softmax(x, axis=-1):
    return torch.softmax(x, dim=axis)
def _gelu(x):
    return torch.nn.functional.gelu(x, approximate="tanh")
def _silu(x):
    return torch.nn.functional.silu(x)
def _sigmoid(x):
    return torch.sigmoid(x)
def _layernorm(x, axis=-1, eps=1e-5):
    m = x.mean(dim=axis, keepdim=True)
    v = x.var(dim=axis, keepdim=True, unbiased=False)
    return (x - m) / torch.sqrt(v + eps)
def _scatter_add(tgt, idx, src, axis=0):
    return tgt.clone().index_add_(axis, idx, src)
def _segment_sum(src, seg, n):
    out = torch.zeros((n,) + src.shape[1:], dtype=src.dtype)
    return out.index_add_(0, seg, src)
def _pad(x, pw):
    flat = tuple(v for pair in reversed(pw) for v in pair)
    return torch.nn.functional.pad(x, flat)

kernel_name = 'recurrent_scan__mha_block_cached__glu_gated_glu__decode'

def setup_inputs():

    _w = (lambda a: (lambda t: t.to(torch.bfloat16) if t.is_floating_point() else t)(torch.as_tensor(a)))
    def _A_setup():
        B, Sq, D = 1, 1, 512
        H, Sk, Dh = 32, 8192, 128
        return {
            "x": _w((lambda *s: torch.randn(*s, dtype=torch.bfloat16) * 0.05)(B, Sq, D)),
            "k_cache": _w((lambda *s: torch.randn(*s, dtype=torch.bfloat16) * 0.8)(B, H, Sk, Dh)),
            "v_cache": _w((lambda *s: torch.randn(*s, dtype=torch.bfloat16) * 0.8)(B, H, Sk, Dh)),
            "wq": _w((lambda *s: torch.randn(*s, dtype=torch.bfloat16) * 0.8)(D, H * Dh) * (D ** -0.5)),
            "wo": _w((lambda *s: torch.randn(*s, dtype=torch.bfloat16) * 0.8)(H * Dh, D) * ((H * Dh) ** -0.5)),
        }
    _A_in = _A_setup()

    def _B_setup():
        B, S, D, F = 1, 1, 512, 1376
        return {
            "x": _w((lambda *s: torch.randn(*s, dtype=torch.bfloat16) * 0.05)(B, S, D)),
            "w_gate": _w((lambda *s: torch.randn(*s, dtype=torch.bfloat16) * 0.8)(D, F)),
            "w_up": _w((lambda *s: torch.randn(*s, dtype=torch.bfloat16) * 0.2)(D, F)),
            "w_down": _w((lambda *s: torch.randn(*s, dtype=torch.bfloat16) * 0.2)(F, D)),
        }
    _B_in = _B_setup()

    return {
        "A_x": _A_in["x"],
        "A_k_cache": _A_in["k_cache"],
        "A_v_cache": _A_in["v_cache"],
        "A_wq": _A_in["wq"],
        "A_wo": _A_in["wo"],
        "B_x": _B_in["x"],
        "B_w_gate": _B_in["w_gate"],
        "B_w_up": _B_in["w_up"],
        "B_w_down": _B_in["w_down"],
    }

def reference(A_x, A_k_cache, A_v_cache, A_wq, A_wo, B_x, B_w_gate, B_w_up, B_w_down):
    def _A_ref(x, k_cache, v_cache, wq, wo):
        B, Sq, D = x.shape
        H, Dh = 32, 128
        q = (lambda x, *d: x.permute(*d))((x @ wq).reshape(B, Sq, H, Dh), 0, 2, 1, 3)
        scores = torch.einsum("bhqd,bhkd->bhqk", q, k_cache) * (Dh ** -0.5)
        p = _softmax(scores, axis=-1)
        o = torch.einsum("bhqk,bhkd->bhqd", p, v_cache)
        return (lambda x, *d: x.permute(*d))(o, 0, 2, 1, 3).reshape(B, Sq, H * Dh) @ wo

    def _B_ref(x, w_gate, w_up, w_down):
        g = torch.einsum("bsd,df->bsf", x, w_gate)
        u = torch.einsum("bsd,df->bsf", x, w_up)
        h = _sigmoid(g) * u
        return torch.einsum("bsf,fd->bsd", h, w_down)

    x = A_x
    xn = _layernorm(x, axis=-1)
    s = _A_ref(xn, A_k_cache, A_v_cache, A_wq, A_wo)
    g = _silu(_B_ref(xn, B_w_gate, B_w_up, B_w_down))
    return x + s * g
```

```asm
; @launch grid=(256,1,1) block=(384,1,1) lds=3072
.amdgcn_target "amdgcn-amd-amdhsa--gfx950"
.text
.globl recurrent_scan__mha_block_cached__glu_gated_glu__decode_kernel
.p2align 8
.type recurrent_scan__mha_block_cached__glu_gated_glu__decode_kernel,@function
recurrent_scan__mha_block_cached__glu_gated_glu__decode_kernel:
    s_load_dwordx2 s[8:9], s[0:1], 8
    s_load_dwordx2 s[12:13], s[0:1], 16
    v_lshrrev_b32 v1, 6, v0
    s_cmp_ge_u32 s2, 256
    s_cbranch_scc1 L_end
    v_readfirstlane_b32 s3, v1
    s_and_b32 s4, s2, 31
    s_lshr_b32 s5, s2, 5
    v_and_b32 v0, 63, v0
    s_mov_b32 s50, 0xffff
    s_cmp_eq_u32 s3, 4
    s_cbranch_scc1 L_service
    s_cmp_eq_u32 s3, 5
    s_cbranch_scc1 L_claim
    s_mov_b32 s10, 67108864
    s_mov_b32 s11, 0x20000
    s_mov_b32 s14, 67108864
    s_mov_b32 s15, 0x20000
    s_lshl_b32 s48, s4, 21
    s_lshl_b32 s49, s5, 18
    s_add_u32 s48, s48, s49
    s_lshl_b32 s49, s3, 12
    s_add_u32 s48, s48, s49
    v_lshlrev_b32 v1, 4, v0
    s_mov_b32 s49, s48
    s_waitcnt lgkmcnt(0)
    buffer_load_dwordx4 v[48:51], v1, s[8:11], s49 offen nt
    buffer_load_dwordx4 v[52:55], v1, s[8:11], s49 offen offset:1024 nt
    buffer_load_dwordx4 v[56:59], v1, s[8:11], s49 offen offset:2048 nt
    buffer_load_dwordx4 v[60:63], v1, s[8:11], s49 offen offset:3072 nt
    s_branch L_stream
L_service:
    s_load_dwordx2 s[16:17], s[0:1], 0
    s_mov_b32 s18, 1024
    s_mov_b32 s19, 0x20000
    s_load_dwordx2 s[20:21], s[0:1], 24
    s_mov_b32 s22, 4194304
    s_mov_b32 s23, 0x20000
    s_load_dwordx2 s[40:41], s[0:1], 88
    s_mov_b32 s42, 268435456
    s_mov_b32 s43, 0x20000
    s_load_dwordx4 s[44:47], s[0:1], 48
    s_load_dwordx2 s[24:25], s[0:1], 32
    s_mov_b32 s26, 4194304
    s_mov_b32 s27, 0x20000
    s_load_dwordx2 s[28:29], s[0:1], 64
    s_mov_b32 s30, 1409024
    s_mov_b32 s31, 0x20000
    s_load_dwordx2 s[32:33], s[0:1], 72
    s_mov_b32 s34, 1024
    s_mov_b32 s35, 0x20000
    v_lshrrev_b32 v1, 4, v0
    v_and_b32 v2, 15, v0
    s_and_b32 s7, s4, 7
    s_lshl_b32 s7, s7, 2
    s_lshr_b32 s48, s4, 3
    s_add_u32 s7, s7, s48
    s_mul_i32 s56, s7, 43
    s_add_u32 s57, s56, 43
    s_lshr_b32 s56, s56, 3
    s_lshr_b32 s57, s57, 3
    s_sub_u32 s57, s57, s56
    v_lshlrev_b32 v63, 4, v0
    s_lshl_b32 s48, s5, 7
    v_lshlrev_b32 v25, 1, v0
    v_lshlrev_b32 v27, 4, v2
    v_lshl_add_u32 v26, v1, 17, v27
    s_lshl_b32 s49, s5, 19
    s_lshl_b32 s51, s4, 8
    s_add_u32 s49, s49, s51
    v_and_b32 v28, 7, v0
    v_cmp_gt_u32 vcc, s57, v28
    s_mov_b32 s51, 44032
    s_mul_i32 s58, s5, 176128
    v_cndmask_b32 v28, 0, v28, vcc
    v_add_lshl_u32 v28, v28, s56, 4
    v_mad_u32_u24 v28, v1, s51, v28
    v_add_u32 v28, s58, v28
    v_mov_b32 v29, 0
    v_cmp_lt_u32 vcc, 7, v2
    s_mov_b32 s79, 720896
    s_mov_b32 s60, 5504
    s_mov_b32 s61, 0
    s_waitcnt lgkmcnt(0)
    buffer_load_dwordx4 v[40:43], v63, s[16:19], 0 offen
    buffer_load_ushort v44, v25, s[16:19], s48 offen
    buffer_load_dword v45, v29, s[40:43], s79 offen sc1
    v_mov_b32 v30, s44
    v_mov_b32 v31, s45
    v_mov_b32 v32, s46
    v_mov_b32 v33, s47
    v_cndmask_b32 v46, v30, v32, vcc
    v_cndmask_b32 v47, v31, v33, vcc
    v_lshl_add_u64 v[46:47], v[28:29], 0, v[46:47]
    buffer_load_dwordx4 v[64:67], v26, s[20:23], s49 offen nt
    global_load_dwordx4 v[128:131], v[46:47], off
    s_addk_i32 s49, 0x2000
    buffer_load_dwordx4 v[68:71], v26, s[20:23], s49 offen nt
    global_load_dwordx4 v[132:135], v[46:47], off offset:2752
    s_addk_i32 s49, 0x2000
    v_lshl_add_u64 v[46:47], v[46:47], 0, s[60:61]
    buffer_load_dwordx4 v[72:75], v26, s[20:23], s49 offen nt
    global_load_dwordx4 v[136:139], v[46:47], off
    s_addk_i32 s49, 0x2000
    buffer_load_dwordx4 v[76:79], v26, s[20:23], s49 offen nt
    global_load_dwordx4 v[140:143], v[46:47], off offset:2752
    s_addk_i32 s49, 0x2000
    v_lshl_add_u64 v[46:47], v[46:47], 0, s[60:61]
    buffer_load_dwordx4 v[80:83], v26, s[20:23], s49 offen nt
    global_load_dwordx4 v[144:147], v[46:47], off
    s_addk_i32 s49, 0x2000
    buffer_load_dwordx4 v[84:87], v26, s[20:23], s49 offen nt
    global_load_dwordx4 v[148:151], v[46:47], off offset:2752
    s_addk_i32 s49, 0x2000
    v_lshl_add_u64 v[46:47], v[46:47], 0, s[60:61]
    buffer_load_dwordx4 v[88:91], v26, s[20:23], s49 offen nt
    global_load_dwordx4 v[152:155], v[46:47], off
    s_addk_i32 s49, 0x2000
    buffer_load_dwordx4 v[92:95], v26, s[20:23], s49 offen nt
    global_load_dwordx4 v[156:159], v[46:47], off offset:2752
    s_addk_i32 s49, 0x2000
    v_lshl_add_u64 v[46:47], v[46:47], 0, s[60:61]
    buffer_load_dwordx4 v[96:99], v26, s[20:23], s49 offen nt
    global_load_dwordx4 v[160:163], v[46:47], off
    s_addk_i32 s49, 0x2000
    buffer_load_dwordx4 v[100:103], v26, s[20:23], s49 offen nt
    global_load_dwordx4 v[164:167], v[46:47], off offset:2752
    s_addk_i32 s49, 0x2000
    v_lshl_add_u64 v[46:47], v[46:47], 0, s[60:61]
    buffer_load_dwordx4 v[104:107], v26, s[20:23], s49 offen nt
    global_load_dwordx4 v[168:171], v[46:47], off
    s_addk_i32 s49, 0x2000
    buffer_load_dwordx4 v[108:111], v26, s[20:23], s49 offen nt
    global_load_dwordx4 v[172:175], v[46:47], off offset:2752
    s_addk_i32 s49, 0x2000
    v_lshl_add_u64 v[46:47], v[46:47], 0, s[60:61]
    buffer_load_dwordx4 v[112:115], v26, s[20:23], s49 offen nt
    global_load_dwordx4 v[176:179], v[46:47], off
    s_addk_i32 s49, 0x2000
    buffer_load_dwordx4 v[116:119], v26, s[20:23], s49 offen nt
    global_load_dwordx4 v[180:183], v[46:47], off offset:2752
    s_addk_i32 s49, 0x2000
    v_lshl_add_u64 v[46:47], v[46:47], 0, s[60:61]
    buffer_load_dwordx4 v[120:123], v26, s[20:23], s49 offen nt
    global_load_dwordx4 v[184:187], v[46:47], off
    s_addk_i32 s49, 0x2000
    buffer_load_dwordx4 v[124:127], v26, s[20:23], s49 offen nt
    global_load_dwordx4 v[188:191], v[46:47], off offset:2752
    v_cmp_gt_u32 vcc, 8, v0
    v_lshlrev_b32 v31, 2, v0
    s_mov_b32 s7, 0xfffffc00
    v_cndmask_b32 v30, 0, -1, vcc
    s_mov_b64 exec, 0xffff
    ds_write_b32 v31, v30 offset:256
    s_mov_b64 exec, -1
    ds_write_b32 v29, v29 offset:592
    s_waitcnt lgkmcnt(0)
    s_barrier
    v_and_b32 v30, 1, v0
    v_lshlrev_b32 v30, 4, v30
    v_lshlrev_b32 v30, v30, s50
    v_bfe_u32 v31, v0, 1, 2
    v_cmp_eq_u32 s[84:85], 0, v31
    v_cmp_eq_u32 s[86:87], 1, v31
    v_cmp_eq_u32 s[88:89], 2, v31
    v_cmp_eq_u32 s[90:91], 3, v31
    v_cndmask_b32 v4, 0, v30, s[84:85]
    v_cndmask_b32 v5, 0, v30, s[86:87]
    v_cndmask_b32 v6, 0, v30, s[88:89]
    v_cndmask_b32 v7, 0, v30, s[90:91]
    s_and_b32 s58, s5, 3
    s_lshr_b32 s59, s5, 2
    s_lshl_b32 s6, s4, 3
    s_add_u32 s6, s6, s5
    v_lshlrev_b32 v48, 5, v2
    v_and_b32 v24, 16, v0
    v_add_u32 v48, v48, v24
    s_lshl_b32 s63, s6, 9
    s_add_u32 s63, s63, 262144
    s_lshl_b32 s64, s5, 5
    s_add_u32 s64, s64, s4
    s_lshl_b32 s64, s64, 8
    s_add_u32 s65, s64, 524288
    s_add_u32 s64, s64, 393216
    s_lshl_b32 s66, s6, 4
    s_add_u32 s66, s66, 655360
    s_lshl_b32 s67, s6, 10
    s_mov_b32 s68, 0
    s_mov_b32 s69, -1
    s_waitcnt vmcnt(32)
    v_lshlrev_b32 v24, 16, v40
    v_and_b32 v25, 0xffff0000, v40
    v_lshlrev_b32 v26, 16, v41
    v_and_b32 v27, 0xffff0000, v41
    v_lshlrev_b32 v28, 16, v42
    v_and_b32 v29, 0xffff0000, v42
    v_lshlrev_b32 v30, 16, v43
    v_and_b32 v31, 0xffff0000, v43
    v_add_f32 v32, v24, v25
    v_add_f32 v33, v26, v27
    v_add_f32 v34, v28, v29
    v_add_f32 v35, v30, v31
    v_add_f32 v32, v32, v33
    v_add_f32 v34, v34, v35
    v_add_f32 v32, v32, v34
    v_add_u32 v45, 1, v45
    v_and_b32 v61, 0x3ff, v45
    v_mov_b32 v36, 0
    v_lshl_or_b32 v37, v45, 5, 31
    ds_write_b32 v36, v37 offset:592
    v_readfirstlane_b32 s13, v61
    s_nop 0
    s_sub_u32 s14, 0, s13
    s_subb_u32 s15, 0, s13
    v_add_f32_dpp v32, v32, v32 quad_perm:[1,0,3,2] row_mask:0xf bank_mask:0xf
    s_nop 1
    v_add_f32_dpp v32, v32, v32 quad_perm:[2,3,0,1] row_mask:0xf bank_mask:0xf
    s_nop 1
    v_add_f32_dpp v32, v32, v32 row_half_mirror row_mask:0xf bank_mask:0xf
    s_nop 1
    v_add_f32_dpp v32, v32, v32 row_mirror row_mask:0xf bank_mask:0xf
    s_nop 1
    v_add_f32_dpp v32, v32, v32 row_bcast:15 row_mask:0xa bank_mask:0xf
    s_nop 1
    v_add_f32_dpp v32, v32, v32 row_bcast:31 row_mask:0xc bank_mask:0xf
    v_mul_f32 v32, 0x3b000000, v32
    s_nop 0
    v_readlane_b32 s51, v32, 63
    s_nop 1
    v_subrev_f32 v24, s51, v24
    v_subrev_f32 v25, s51, v25
    v_subrev_f32 v26, s51, v26
    v_subrev_f32 v27, s51, v27
    v_subrev_f32 v28, s51, v28
    v_subrev_f32 v29, s51, v29
    v_subrev_f32 v30, s51, v30
    v_subrev_f32 v31, s51, v31
    v_mul_f32 v33, v24, v24
    v_mul_f32 v34, v25, v25
    v_fmac_f32 v33, v26, v26
    v_fmac_f32 v34, v27, v27
    v_fmac_f32 v33, v28, v28
    v_fmac_f32 v34, v29, v29
    v_fmac_f32 v33, v30, v30
    v_fmac_f32 v34, v31, v31
    v_add_f32 v33, v33, v34
    v_cvt_pk_bf16_f32 v32, v32, v32
    v_and_b32 v32, 0xffff0000, v32
    v_add_f32_dpp v33, v33, v33 quad_perm:[1,0,3,2] row_mask:0xf bank_mask:0xf
    s_nop 1
    v_add_f32_dpp v33, v33, v33 quad_perm:[2,3,0,1] row_mask:0xf bank_mask:0xf
    s_nop 1
    v_add_f32_dpp v33, v33, v33 row_half_mirror row_mask:0xf bank_mask:0xf
    s_nop 1
    v_add_f32_dpp v33, v33, v33 row_mirror row_mask:0xf bank_mask:0xf
    s_nop 1
    v_add_f32_dpp v33, v33, v33 row_bcast:15 row_mask:0xa bank_mask:0xf
    s_nop 1
    v_add_f32_dpp v33, v33, v33 row_bcast:31 row_mask:0xc bank_mask:0xf
    v_mul_f32 v33, 0x3b000000, v33
    v_cvt_pk_bf16_f32 v33, v33, v33
    v_and_b32 v33, 0xffff0000, v33
    v_add_f32 v33, 0x3727c5ac, v33
    v_cvt_pk_bf16_f32 v33, v33, v33
    v_and_b32 v33, 0xffff0000, v33
    v_sqrt_f32 v33, v33
    v_readlane_b32 s51, v32, 63
    v_cvt_pk_bf16_f32 v33, v33, v33
    v_and_b32 v33, 0xffff0000, v33
    v_lshlrev_b32 v44, 16, v44
    v_readlane_b32 s62, v33, 63
    v_subrev_f32 v44, s51, v44
    v_cvt_pk_bf16_f32 v44, v44, v44
    v_and_b32 v44, 0xffff0000, v44
    v_rcp_f32 v34, s62
    s_nop 0
    v_mul_f32 v35, v44, v34
    v_fma_f32 v36, -v35, s62, v44
    v_fmac_f32 v35, v36, v34
    v_cvt_pk_bf16_f32 v3, v35, v35
    s_nop 1
    v_and_b32_dpp v8, v3, v4 row_newbcast:0 row_mask:0xf bank_mask:0xf
    v_and_b32_dpp v9, v3, v5 row_newbcast:0 row_mask:0xf bank_mask:0xf
    v_and_b32_dpp v10, v3, v6 row_newbcast:0 row_mask:0xf bank_mask:0xf
    v_and_b32_dpp v11, v3, v7 row_newbcast:0 row_mask:0xf bank_mask:0xf
    v_and_b32_dpp v12, v3, v4 row_newbcast:1 row_mask:0xf bank_mask:0xf
    v_and_b32_dpp v13, v3, v5 row_newbcast:1 row_mask:0xf bank_mask:0xf
    v_and_b32_dpp v14, v3, v6 row_newbcast:1 row_mask:0xf bank_mask:0xf
    v_and_b32_dpp v15, v3, v7 row_newbcast:1 row_mask:0xf bank_mask:0xf
    s_waitcnt vmcnt(30)
    v_mfma_f32_16x16x32_bf16 v[16:19], v[8:11], v[64:67], 0
    v_mfma_f32_16x16x32_bf16 v[20:23], v[8:11], v[128:131], 0
    v_and_b32_dpp v8, v3, v4 row_newbcast:2 row_mask:0xf bank_mask:0xf
    v_and_b32_dpp v9, v3, v5 row_newbcast:2 row_mask:0xf bank_mask:0xf
    v_and_b32_dpp v10, v3, v6 row_newbcast:2 row_mask:0xf bank_mask:0xf
    v_and_b32_dpp v11, v3, v7 row_newbcast:2 row_mask:0xf bank_mask:0xf
    s_waitcnt vmcnt(28)
    v_mfma_f32_16x16x32_bf16 v[16:19], v[12:15], v[68:71], v[16:19]
    v_mfma_f32_16x16x32_bf16 v[20:23], v[12:15], v[132:135], v[20:23]
    v_and_b32_dpp v12, v3, v4 row_newbcast:3 row_mask:0xf bank_mask:0xf
    v_and_b32_dpp v13, v3, v5 row_newbcast:3 row_mask:0xf bank_mask:0xf
    v_and_b32_dpp v14, v3, v6 row_newbcast:3 row_mask:0xf bank_mask:0xf
    v_and_b32_dpp v15, v3, v7 row_newbcast:3 row_mask:0xf bank_mask:0xf
    s_waitcnt vmcnt(26)
    v_mfma_f32_16x16x32_bf16 v[16:19], v[8:11], v[72:75], v[16:19]
    v_mfma_f32_16x16x32_bf16 v[20:23], v[8:11], v[136:139], v[20:23]
    v_and_b32_dpp v8, v3, v4 row_newbcast:4 row_mask:0xf bank_mask:0xf
    v_and_b32_dpp v9, v3, v5 row_newbcast:4 row_mask:0xf bank_mask:0xf
    v_and_b32_dpp v10, v3, v6 row_newbcast:4 row_mask:0xf bank_mask:0xf
    v_and_b32_dpp v11, v3, v7 row_newbcast:4 row_mask:0xf bank_mask:0xf
    s_waitcnt vmcnt(24)
    v_mfma_f32_16x16x32_bf16 v[16:19], v[12:15], v[76:79], v[16:19]
    v_mfma_f32_16x16x32_bf16 v[20:23], v[12:15], v[140:143], v[20:23]
    v_and_b32_dpp v12, v3, v4 row_newbcast:5 row_mask:0xf bank_mask:0xf
    v_and_b32_dpp v13, v3, v5 row_newbcast:5 row_mask:0xf bank_mask:0xf
    v_and_b32_dpp v14, v3, v6 row_newbcast:5 row_mask:0xf bank_mask:0xf
    v_and_b32_dpp v15, v3, v7 row_newbcast:5 row_mask:0xf bank_mask:0xf
    s_waitcnt vmcnt(22)
    v_mfma_f32_16x16x32_bf16 v[16:19], v[8:11], v[80:83], v[16:19]
    v_mfma_f32_16x16x32_bf16 v[20:23], v[8:11], v[144:147], v[20:23]
    v_and_b32_dpp v8, v3, v4 row_newbcast:6 row_mask:0xf bank_mask:0xf
    v_and_b32_dpp v9, v3, v5 row_newbcast:6 row_mask:0xf bank_mask:0xf
    v_and_b32_dpp v10, v3, v6 row_newbcast:6 row_mask:0xf bank_mask:0xf
    v_and_b32_dpp v11, v3, v7 row_newbcast:6 row_mask:0xf bank_mask:0xf
    s_waitcnt vmcnt(20)
    v_mfma_f32_16x16x32_bf16 v[16:19], v[12:15], v[84:87], v[16:19]
    v_mfma_f32_16x16x32_bf16 v[20:23], v[12:15], v[148:151], v[20:23]
    v_and_b32_dpp v12, v3, v4 row_newbcast:7 row_mask:0xf bank_mask:0xf
    v_and_b32_dpp v13, v3, v5 row_newbcast:7 row_mask:0xf bank_mask:0xf
    v_and_b32_dpp v14, v3, v6 row_newbcast:7 row_mask:0xf bank_mask:0xf
    v_and_b32_dpp v15, v3, v7 row_newbcast:7 row_mask:0xf bank_mask:0xf
    s_waitcnt vmcnt(18)
    v_mfma_f32_16x16x32_bf16 v[16:19], v[8:11], v[88:91], v[16:19]
    v_mfma_f32_16x16x32_bf16 v[20:23], v[8:11], v[152:155], v[20:23]
    v_and_b32_dpp v8, v3, v4 row_newbcast:8 row_mask:0xf bank_mask:0xf
    v_and_b32_dpp v9, v3, v5 row_newbcast:8 row_mask:0xf bank_mask:0xf
    v_and_b32_dpp v10, v3, v6 row_newbcast:8 row_mask:0xf bank_mask:0xf
    v_and_b32_dpp v11, v3, v7 row_newbcast:8 row_mask:0xf bank_mask:0xf
    s_waitcnt vmcnt(16)
    v_mfma_f32_16x16x32_bf16 v[16:19], v[12:15], v[92:95], v[16:19]
    v_mfma_f32_16x16x32_bf16 v[20:23], v[12:15], v[156:159], v[20:23]
    v_and_b32_dpp v12, v3, v4 row_newbcast:9 row_mask:0xf bank_mask:0xf
    v_and_b32_dpp v13, v3, v5 row_newbcast:9 row_mask:0xf bank_mask:0xf
    v_and_b32_dpp v14, v3, v6 row_newbcast:9 row_mask:0xf bank_mask:0xf
    v_and_b32_dpp v15, v3, v7 row_newbcast:9 row_mask:0xf bank_mask:0xf
    s_waitcnt vmcnt(14)
    v_mfma_f32_16x16x32_bf16 v[16:19], v[8:11], v[96:99], v[16:19]
    v_mfma_f32_16x16x32_bf16 v[20:23], v[8:11], v[160:163], v[20:23]
    v_and_b32_dpp v8, v3, v4 row_newbcast:10 row_mask:0xf bank_mask:0xf
    v_and_b32_dpp v9, v3, v5 row_newbcast:10 row_mask:0xf bank_mask:0xf
    v_and_b32_dpp v10, v3, v6 row_newbcast:10 row_mask:0xf bank_mask:0xf
    v_and_b32_dpp v11, v3, v7 row_newbcast:10 row_mask:0xf bank_mask:0xf
    s_waitcnt vmcnt(12)
    v_mfma_f32_16x16x32_bf16 v[16:19], v[12:15], v[100:103], v[16:19]
    v_mfma_f32_16x16x32_bf16 v[20:23], v[12:15], v[164:167], v[20:23]
    v_and_b32_dpp v12, v3, v4 row_newbcast:11 row_mask:0xf bank_mask:0xf
    v_and_b32_dpp v13, v3, v5 row_newbcast:11 row_mask:0xf bank_mask:0xf
    v_and_b32_dpp v14, v3, v6 row_newbcast:11 row_mask:0xf bank_mask:0xf
    v_and_b32_dpp v15, v3, v7 row_newbcast:11 row_mask:0xf bank_mask:0xf
    s_waitcnt vmcnt(10)
    v_mfma_f32_16x16x32_bf16 v[16:19], v[8:11], v[104:107], v[16:19]
    v_mfma_f32_16x16x32_bf16 v[20:23], v[8:11], v[168:171], v[20:23]
    v_and_b32_dpp v8, v3, v4 row_newbcast:12 row_mask:0xf bank_mask:0xf
    v_and_b32_dpp v9, v3, v5 row_newbcast:12 row_mask:0xf bank_mask:0xf
    v_and_b32_dpp v10, v3, v6 row_newbcast:12 row_mask:0xf bank_mask:0xf
    v_and_b32_dpp v11, v3, v7 row_newbcast:12 row_mask:0xf bank_mask:0xf
    s_waitcnt vmcnt(8)
    v_mfma_f32_16x16x32_bf16 v[16:19], v[12:15], v[108:111], v[16:19]
    v_mfma_f32_16x16x32_bf16 v[20:23], v[12:15], v[172:175], v[20:23]
    v_and_b32_dpp v12, v3, v4 row_newbcast:13 row_mask:0xf bank_mask:0xf
    v_and_b32_dpp v13, v3, v5 row_newbcast:13 row_mask:0xf bank_mask:0xf
    v_and_b32_dpp v14, v3, v6 row_newbcast:13 row_mask:0xf bank_mask:0xf
    v_and_b32_dpp v15, v3, v7 row_newbcast:13 row_mask:0xf bank_mask:0xf
    s_waitcnt vmcnt(6)
    v_mfma_f32_16x16x32_bf16 v[16:19], v[8:11], v[112:115], v[16:19]
    v_mfma_f32_16x16x32_bf16 v[20:23], v[8:11], v[176:179], v[20:23]
    v_and_b32_dpp v8, v3, v4 row_newbcast:14 row_mask:0xf bank_mask:0xf
    v_and_b32_dpp v9, v3, v5 row_newbcast:14 row_mask:0xf bank_mask:0xf
    v_and_b32_dpp v10, v3, v6 row_newbcast:14 row_mask:0xf bank_mask:0xf
    v_and_b32_dpp v11, v3, v7 row_newbcast:14 row_mask:0xf bank_mask:0xf
    s_waitcnt vmcnt(4)
    v_mfma_f32_16x16x32_bf16 v[16:19], v[12:15], v[116:119], v[16:19]
    v_mfma_f32_16x16x32_bf16 v[20:23], v[12:15], v[180:183], v[20:23]
    v_and_b32_dpp v12, v3, v4 row_newbcast:15 row_mask:0xf bank_mask:0xf
    v_and_b32_dpp v13, v3, v5 row_newbcast:15 row_mask:0xf bank_mask:0xf
    v_and_b32_dpp v14, v3, v6 row_newbcast:15 row_mask:0xf bank_mask:0xf
    v_and_b32_dpp v15, v3, v7 row_newbcast:15 row_mask:0xf bank_mask:0xf
    s_waitcnt vmcnt(2)
    v_mfma_f32_16x16x32_bf16 v[16:19], v[8:11], v[120:123], v[16:19]
    v_mfma_f32_16x16x32_bf16 v[20:23], v[8:11], v[184:187], v[20:23]
    s_waitcnt vmcnt(0)
    v_mfma_f32_16x16x32_bf16 v[16:19], v[12:15], v[124:127], v[16:19]
    v_mfma_f32_16x16x32_bf16 v[20:23], v[12:15], v[188:191], v[20:23]
    s_lshl_b32 s48, s4, 13
    s_add_u32 s49, s48, 0x1000
    v_lshrrev_b32 v27, 1, v48
    s_nop 4
    v_cndmask_b32 v16, v16, v20, s[68:69]
    v_cndmask_b32 v17, v17, v21, s[68:69]
    v_cndmask_b32 v18, v18, v22, s[68:69]
    v_cndmask_b32 v19, v19, v23, s[68:69]
    v_add_u32 v16, 0x200, v16
    v_add_u32 v17, 0x200, v17
    v_add_u32 v18, 0x200, v18
    v_add_u32 v19, 0x200, v19
    v_and_or_b32 v16, v16, s7, v61
    v_and_or_b32 v17, v17, s7, v61
    v_and_or_b32 v18, v18, s7, v61
    v_and_or_b32 v19, v19, s7, v61
    buffer_store_dwordx4 v[16:19], v63, s[40:43], s67 offen sc1
    s_mov_b32 s70, 2097152
L_pollA:
    s_sleep 40
    buffer_load_dwordx4 v[64:67], v63, s[40:43], s48 offen sc1
    buffer_load_dwordx4 v[68:71], v63, s[40:43], s48 offen offset:1024 sc1
    buffer_load_dwordx4 v[72:75], v63, s[40:43], s48 offen offset:2048 sc1
    buffer_load_dwordx4 v[76:79], v63, s[40:43], s48 offen offset:3072 sc1
    buffer_load_dwordx4 v[80:83], v63, s[40:43], s49 offen sc1
    buffer_load_dwordx4 v[84:87], v63, s[40:43], s49 offen offset:1024 sc1
    buffer_load_dwordx4 v[88:91], v63, s[40:43], s49 offen offset:2048 sc1
    buffer_load_dwordx4 v[92:95], v63, s[40:43], s49 offen offset:3072 sc1
    s_sub_u32 s70, s70, 1
    s_cbranch_scc1 L_pollA_done
    s_waitcnt vmcnt(0)
    v_bitop3_b32 v24, v64, v65, v61 bitop3:0x7e
    v_bitop3_b32 v25, v66, v67, v61 bitop3:0x7e
    v_bitop3_b32 v26, v68, v69, v61 bitop3:0x7e
    v_or3_b32 v24, v24, v25, v26
    v_bitop3_b32 v25, v70, v71, v61 bitop3:0x7e
    v_bitop3_b32 v26, v72, v73, v61 bitop3:0x7e
    v_or3_b32 v24, v24, v25, v26
    v_bitop3_b32 v25, v74, v75, v61 bitop3:0x7e
    v_bitop3_b32 v26, v76, v77, v61 bitop3:0x7e
    v_or3_b32 v24, v24, v25, v26
    v_bitop3_b32 v25, v78, v79, v61 bitop3:0x7e
    v_bitop3_b32 v26, v80, v81, v61 bitop3:0x7e
    v_or3_b32 v24, v24, v25, v26
    v_bitop3_b32 v25, v82, v83, v61 bitop3:0x7e
    v_bitop3_b32 v26, v84, v85, v61 bitop3:0x7e
    v_or3_b32 v24, v24, v25, v26
    v_bitop3_b32 v25, v86, v87, v61 bitop3:0x7e
    v_bitop3_b32 v26, v88, v89, v61 bitop3:0x7e
    v_or3_b32 v24, v24, v25, v26
    v_bitop3_b32 v25, v90, v91, v61 bitop3:0x7e
    v_bitop3_b32 v26, v92, v93, v61 bitop3:0x7e
    v_or3_b32 v24, v24, v25, v26
    v_bitop3_b32 v25, v94, v95, v61 bitop3:0x7e
    v_or_b32 v24, v24, v25
    v_and_b32 v24, 0x3ff, v24
    v_cmp_ne_u32 vcc, 0, v24
    s_nop 1
    s_cbranch_vccnz L_pollA
L_pollA_done:
    v_and_b32 v64, s7, v64
    v_and_b32 v65, s7, v65
    v_and_b32 v66, s7, v66
    v_and_b32 v67, s7, v67
    v_and_b32 v68, s7, v68
    v_and_b32 v69, s7, v69
    v_and_b32 v70, s7, v70
    v_and_b32 v71, s7, v71
    v_and_b32 v72, s7, v72
    v_and_b32 v73, s7, v73
    v_and_b32 v74, s7, v74
    v_and_b32 v75, s7, v75
    v_and_b32 v76, s7, v76
    v_and_b32 v77, s7, v77
    v_and_b32 v78, s7, v78
    v_and_b32 v79, s7, v79
    v_and_b32 v80, s7, v80
    v_and_b32 v81, s7, v81
    v_and_b32 v82, s7, v82
    v_and_b32 v83, s7, v83
    v_and_b32 v84, s7, v84
    v_and_b32 v85, s7, v85
    v_and_b32 v86, s7, v86
    v_and_b32 v87, s7, v87
    v_and_b32 v88, s7, v88
    v_and_b32 v89, s7, v89
    v_and_b32 v90, s7, v90
    v_and_b32 v91, s7, v91
    v_and_b32 v92, s7, v92
    v_and_b32 v93, s7, v93
    v_and_b32 v94, s7, v94
    v_and_b32 v95, s7, v95
    v_add_f32 v64, v64, v68
    v_add_f32 v72, v72, v76
    v_add_f32 v80, v80, v84
    v_add_f32 v88, v88, v92
    v_add_f32 v65, v65, v69
    v_add_f32 v73, v73, v77
    v_add_f32 v81, v81, v85
    v_add_f32 v89, v89, v93
    v_add_f32 v66, v66, v70
    v_add_f32 v74, v74, v78
    v_add_f32 v82, v82, v86
    v_add_f32 v90, v90, v94
    v_add_f32 v67, v67, v71
    v_add_f32 v75, v75, v79
    v_add_f32 v83, v83, v87
    v_add_f32 v91, v91, v95
    v_add_f32 v64, v64, v72
    v_add_f32 v80, v80, v88
    v_add_f32 v65, v65, v73
    v_add_f32 v81, v81, v89
    v_add_f32 v66, v66, v74
    v_add_f32 v82, v82, v90
    v_add_f32 v67, v67, v75
    v_add_f32 v83, v83, v91
    v_add_f32 v64, v64, v80
    v_add_f32 v65, v65, v81
    v_add_f32 v66, v66, v82
    v_add_f32 v67, v67, v83
    v_cvt_pk_bf16_f32 v28, v64, v65
    v_cvt_pk_bf16_f32 v29, v66, v67
    v_mov_b32 v30, 0
    v_mov_b32 v31, 1
    s_mov_b32 exec_hi, 0
    ds_write_b64 v27, v[28:29] offset:0
    ds_write_b32 v30, v31 offset:304
    s_mov_b64 exec, -1
    v_or_b32 v53, v4, v6
    v_or_b32 v55, v5, v7
    v_mul_u32_u24 v24, 12, v1
    s_lshl_b32 s48, s57, 3
    s_lshl_b32 s49, s56, 3
    s_lshl_b32 s72, s5, 7
    v_lshlrev_b32 v26, 3, v2
    v_add_u32 v27, 4, v24
    v_cmp_gt_u32 vcc, s48, v27
    v_add_u32 v27, s49, v24
    v_lshl_add_u32 v27, v27, 10, v26
    v_mov_b32 v52, 0x7ffffff0
    v_cndmask_b32 v52, v52, v27, vcc
    s_add_u32 s48, s72, 0x1000
    s_add_u32 s49, s72, 0x2000
    buffer_load_dwordx2 v[128:129], v27, s[28:31], s72 offen nt
    buffer_load_dwordx2 v[130:131], v27, s[28:31], s72 offen offset:1024 nt
    buffer_load_dwordx2 v[132:133], v27, s[28:31], s72 offen offset:2048 nt
    buffer_load_dwordx2 v[134:135], v27, s[28:31], s72 offen offset:3072 nt
    buffer_load_dwordx2 v[136:137], v52, s[28:31], s48 offen nt
    buffer_load_dwordx2 v[138:139], v52, s[28:31], s48 offen offset:1024 nt
    buffer_load_dwordx2 v[140:141], v52, s[28:31], s48 offen offset:2048 nt
    buffer_load_dwordx2 v[142:143], v52, s[28:31], s48 offen offset:3072 nt
    buffer_load_dwordx2 v[144:145], v52, s[28:31], s49 offen nt
    buffer_load_dwordx2 v[146:147], v52, s[28:31], s49 offen offset:1024 nt
    buffer_load_dwordx2 v[148:149], v52, s[28:31], s49 offen offset:2048 nt
    buffer_load_dwordx2 v[150:151], v52, s[28:31], s49 offen offset:3072 nt
    v_cvt_pk_bf16_f32 v64, v64, v64
    v_and_b32 v64, 0xffff0000, v64
    v_cvt_pk_bf16_f32 v65, v65, v65
    v_and_b32 v65, 0xffff0000, v65
    v_cvt_pk_bf16_f32 v66, v66, v66
    v_and_b32 v66, 0xffff0000, v66
    v_cvt_pk_bf16_f32 v67, v67, v67
    v_and_b32 v67, 0xffff0000, v67
    v_mov_b32_dpp v28, v64 row_ror:8 row_mask:0xf bank_mask:0xf
    v_mov_b32_dpp v29, v65 row_ror:8 row_mask:0xf bank_mask:0xf
    v_mov_b32_dpp v30, v66 row_ror:8 row_mask:0xf bank_mask:0xf
    v_mov_b32_dpp v31, v67 row_ror:8 row_mask:0xf bank_mask:0xf
    v_mul_f32 v64, 0xbfb8aa3b, v64
    v_mul_f32 v65, 0xbfb8aa3b, v65
    v_mul_f32 v66, 0xbfb8aa3b, v66
    v_mul_f32 v67, 0xbfb8aa3b, v67
    v_exp_f32 v64, v64
    v_exp_f32 v65, v65
    v_exp_f32 v66, v66
    v_exp_f32 v67, v67
    v_add_f32 v64, 1.0, v64
    v_add_f32 v65, 1.0, v65
    v_add_f32 v66, 1.0, v66
    v_add_f32 v67, 1.0, v67
    v_rcp_f32 v64, v64
    v_rcp_f32 v65, v65
    v_rcp_f32 v66, v66
    v_rcp_f32 v67, v67
    v_cvt_pk_bf16_f32 v64, v64, v64
    v_and_b32 v64, 0xffff0000, v64
    v_cvt_pk_bf16_f32 v65, v65, v65
    v_and_b32 v65, 0xffff0000, v65
    v_cvt_pk_bf16_f32 v66, v66, v66
    v_and_b32 v66, 0xffff0000, v66
    v_cvt_pk_bf16_f32 v67, v67, v67
    v_and_b32 v67, 0xffff0000, v67
    v_mul_f32 v64, v64, v28
    v_mul_f32 v65, v65, v29
    v_mul_f32 v66, v66, v30
    v_mul_f32 v67, v67, v31
    v_cmp_gt_u32 vcc, s57, v2
    v_cvt_pk_bf16_f32 v64, v64, v64
    v_cvt_pk_bf16_f32 v65, v65, v65
    v_cvt_pk_bf16_f32 v66, v66, v66
    v_cvt_pk_bf16_f32 v67, v67, v67
    v_cndmask_b32 v64, 0, v64, vcc
    v_cndmask_b32 v65, 0, v65, vcc
    v_cndmask_b32 v66, 0, v66, vcc
    v_cndmask_b32 v67, 0, v67, vcc
    s_mov_b32 exec_lo, 0
    s_mov_b32 exec_hi, 0x00ff00ff
    ds_write_b128 v48, v[64:67] offset:320
    s_mov_b64 exec, -1
    v_add_lshl_u32 v25, v24, v2, 2
    s_waitcnt lgkmcnt(0)
    ds_read_b32 v50, v25 offset:320
    v_lshl_add_u32 v58, v1, 15, v26
    s_lshl_b32 s71, s4, 17
    s_add_u32 s71, s71, s72
    v_and_b32 v27, 3, v0
    s_lshr_b32 s48, s4, 2
    s_and_b32 s49, s4, 3
    v_lshl_add_u32 v28, v27, 2, v1
    s_lshl_b32 s51, s4, 4
    v_add_lshl_u32 v49, v28, s51, 1
    v_lshrrev_b32 v59, 2, v0
    v_lshlrev_b32 v59, 8, v59
    v_lshl_add_u32 v59, v27, 4, v59
    s_lshl_b32 s73, s48, 13
    s_lshl_b32 s49, s49, 6
    s_add_u32 s73, s73, s49
    s_mov_b32 s36, s5
    buffer_load_ushort v51, v49, s[16:19], 0 offen
    v_lshlrev_b32 v60, 3, v0
    s_lshl_b32 s78, s4, 12
    s_add_u32 s78, s78, 262144
    s_waitcnt lgkmcnt(0)
    v_and_b32_dpp v8, v50, v53 row_newbcast:0 row_mask:0xf bank_mask:0xf
    v_and_b32_dpp v9, v50, v55 row_newbcast:0 row_mask:0xf bank_mask:0xf
    v_and_b32_dpp v10, v50, v53 row_newbcast:1 row_mask:0xf bank_mask:0xf
    v_and_b32_dpp v11, v50, v55 row_newbcast:1 row_mask:0xf bank_mask:0xf
    v_and_b32_dpp v12, v50, v53 row_newbcast:2 row_mask:0xf bank_mask:0xf
    v_and_b32_dpp v13, v50, v55 row_newbcast:2 row_mask:0xf bank_mask:0xf
    v_and_b32_dpp v14, v50, v53 row_newbcast:3 row_mask:0xf bank_mask:0xf
    v_and_b32_dpp v15, v50, v55 row_newbcast:3 row_mask:0xf bank_mask:0xf
    s_waitcnt vmcnt(11)
    v_mfma_f32_16x16x32_bf16 v[16:19], v[8:11], v[128:131], 0
    v_and_b32_dpp v8, v50, v53 row_newbcast:4 row_mask:0xf bank_mask:0xf
    v_and_b32_dpp v9, v50, v55 row_newbcast:4 row_mask:0xf bank_mask:0xf
    v_and_b32_dpp v10, v50, v53 row_newbcast:5 row_mask:0xf bank_mask:0xf
    v_and_b32_dpp v11, v50, v55 row_newbcast:5 row_mask:0xf bank_mask:0xf
    s_waitcnt vmcnt(9)
    v_mfma_f32_16x16x32_bf16 v[16:19], v[12:15], v[132:135], v[16:19]
    v_and_b32_dpp v12, v50, v53 row_newbcast:6 row_mask:0xf bank_mask:0xf
    v_and_b32_dpp v13, v50, v55 row_newbcast:6 row_mask:0xf bank_mask:0xf
    v_and_b32_dpp v14, v50, v53 row_newbcast:7 row_mask:0xf bank_mask:0xf
    v_and_b32_dpp v15, v50, v55 row_newbcast:7 row_mask:0xf bank_mask:0xf
    s_waitcnt vmcnt(7)
    v_mfma_f32_16x16x32_bf16 v[16:19], v[8:11], v[136:139], v[16:19]
    v_and_b32_dpp v8, v50, v53 row_newbcast:8 row_mask:0xf bank_mask:0xf
    v_and_b32_dpp v9, v50, v55 row_newbcast:8 row_mask:0xf bank_mask:0xf
    v_and_b32_dpp v10, v50, v53 row_newbcast:9 row_mask:0xf bank_mask:0xf
    v_and_b32_dpp v11, v50, v55 row_newbcast:9 row_mask:0xf bank_mask:0xf
    s_waitcnt vmcnt(5)
    v_mfma_f32_16x16x32_bf16 v[16:19], v[12:15], v[140:143], v[16:19]
    v_and_b32_dpp v12, v50, v53 row_newbcast:10 row_mask:0xf bank_mask:0xf
    v_and_b32_dpp v13, v50, v55 row_newbcast:10 row_mask:0xf bank_mask:0xf
    v_and_b32_dpp v14, v50, v53 row_newbcast:11 row_mask:0xf bank_mask:0xf
    v_and_b32_dpp v15, v50, v55 row_newbcast:11 row_mask:0xf bank_mask:0xf
    s_waitcnt vmcnt(3)
    v_mfma_f32_16x16x32_bf16 v[16:19], v[8:11], v[144:147], v[16:19]
    s_waitcnt vmcnt(1)
    v_mfma_f32_16x16x32_bf16 v[16:19], v[12:15], v[148:151], v[16:19]
    s_mov_b64 exec, 0xffff
    s_nop 6
    v_add_u32 v16, 0x200, v16
    v_add_u32 v17, 0x200, v17
    v_add_u32 v18, 0x200, v18
    v_add_u32 v19, 0x200, v19
    v_and_or_b32 v32, v16, s7, v61
    v_and_or_b32 v33, v17, s7, v61
    v_and_or_b32 v34, v18, s7, v61
    v_and_or_b32 v35, v19, s7, v61
    buffer_store_dwordx4 v[32:35], v63, s[40:43], s65 offen sc1
    s_mov_b64 exec, -1
    s_cmp_lg_u32 s2, 0
    s_cbranch_scc1 L_noprobe
    s_mov_b32 s48, 1572864
    s_mov_b32 s10, -1
    s_mov_b32 s11, -1
    s_mov_b32 s49, 4
    s_load_dword s8, s[40:41], s48
    s_waitcnt lgkmcnt(0)
L_probe_d:
    s_addk_i32 s48, 0x2000
    s_memtime s[56:57]
    s_waitcnt lgkmcnt(0)
    s_load_dword s8, s[40:41], s48
    s_waitcnt lgkmcnt(0)
    s_memtime s[58:59]
    s_waitcnt lgkmcnt(0)
    s_sub_u32 s56, s58, s56
    s_min_u32 s11, s11, s56
    s_addk_i32 s48, 0x2100
    s_memtime s[56:57]
    s_waitcnt lgkmcnt(0)
    s_load_dword s8, s[40:41], s48
    s_waitcnt lgkmcnt(0)
    s_memtime s[58:59]
    s_waitcnt lgkmcnt(0)
    s_sub_u32 s56, s58, s56
    s_min_u32 s10, s10, s56
    s_sub_u32 s49, s49, 1
    s_cmp_lg_u32 s49, 0
    s_cbranch_scc1 L_probe_d
    s_cmp_gt_u32 s10, s11
    s_cselect_b32 s48, 0x400, 0
    v_or_b32 v28, s48, v61
    v_mov_b32 v29, v61
    v_mov_b32 v30, v45
    v_mov_b32 v31, v45
    v_mov_b32 v25, 0
    s_mov_b32 s48, 737280
    s_mov_b64 exec, 1
    buffer_store_dwordx4 v[28:31], v25, s[40:43], s48 offen sc1
    s_mov_b64 exec, -1
L_noprobe:
    v_and_b32 v24, 3, v0
    v_lshlrev_b32 v24, 3, v24
    s_mov_b32 s70, 16777216
L_pollML:
    s_sleep 1
    ds_read_b64 v[26:27], v24 offset:256
    s_sub_u32 s70, s70, 1
    s_cbranch_scc1 L_pollML_done
    s_waitcnt lgkmcnt(0)
    v_cmp_eq_u32 vcc, -1, v27
    s_nop 1
    s_cbranch_vccnz L_pollML
L_pollML_done:
    v_max_f32_dpp v28, v26, v26 quad_perm:[1,0,3,2] row_mask:0xf bank_mask:0xf
    s_nop 1
    v_max_f32_dpp v28, v28, v28 quad_perm:[2,3,0,1] row_mask:0xf bank_mask:0xf
    v_sub_f32 v29, v26, v28
    v_mul_f32 v29, 0x3fb8aa3b, v29
    v_exp_f32 v29, v29
    s_nop 0
    v_mul_f32 v29, v29, v27
    s_nop 1
    v_add_f32_dpp v29, v29, v29 quad_perm:[1,0,3,2] row_mask:0xf bank_mask:0xf
    s_nop 1
    v_add_f32_dpp v29, v29, v29 quad_perm:[2,3,0,1] row_mask:0xf bank_mask:0xf
    v_and_or_b32 v28, v28, s7, v61
    v_and_or_b32 v29, v29, s7, v61
    s_getreg_b32 s37, hwreg(HW_REG_XCC_ID, 0, 4)
    s_lshl_b32 s37, s37, 10
    v_or_b32 v28, s37, v28
    v_mov_b32 v25, 0
    s_mov_b64 exec, 1
    v_mov_b32 v30, v45
    v_mov_b32 v31, v45
    buffer_store_dwordx4 v[28:31], v25, s[40:43], s66 offen sc1
    s_mov_b64 exec, -1
    v_and_b32 v25, 7, v0
    v_lshlrev_b32 v25, 4, v25
    s_lshl_b32 s48, s4, 7
    s_add_u32 s48, s48, 655360
    s_sub_u32 s49, 737280, s48
    v_mov_b32 v32, s49
    s_mov_b32 s56, 0xff00ff00
    s_mov_b32 s57, 0xff00ff00
    v_cndmask_b32 v25, v25, v32, s[56:57]
    v_mov_b32 v32, 0
    s_mov_b32 s70, 16777216
L_pollM:
    s_sleep 4
    ds_read_b32 v28, v32 offset:312
    s_sub_u32 s70, s70, 1
    s_cbranch_scc1 L_pollM_done
    s_waitcnt lgkmcnt(0)
    v_cmp_eq_u32 vcc, 0, v28
    s_nop 1
    s_cbranch_vccnz L_pollM
L_pollM_done:
    s_movk_i32 s12, 0x3ff
    s_mov_b32 s70, 2097152
L_pollML2:
    s_sleep 4
    buffer_load_dwordx4 v[28:31], v25, s[40:43], s48 offen sc1
    s_sub_u32 s70, s70, 1
    s_cbranch_scc1 L_pollML2_done
    s_waitcnt vmcnt(0)
    v_bitop3_b32 v32, v28, v29, v61 bitop3:0x7e
    v_bitop3_b32 v33, v30, v31, v45 bitop3:0x7e
    v_and_or_b32 v32, v32, s12, v33
    v_cmp_ne_u32 vcc, 0, v32
    s_nop 1
    s_cbranch_vccnz L_pollML2
L_pollML2_done:
    v_and_b32 v30, 0x3c00, v28
    v_cmp_ne_u32 vcc, s37, v30
    s_nop 1
    s_and_b32 s37, vcc_lo, 0xff
    v_readlane_b32 s38, v28, 8
    s_nop 0
    s_and_b32 s38, s38, 0x400
    s_lshl_b32 s38, s38, 3
    s_xor_b32 s64, s64, s38
    v_and_b32 v28, 0xffff0000, v28
    v_and_b32 v29, s7, v29
    v_lshlrev_b32 v51, 16, v51
    v_max_f32_dpp v30, v28, v28 quad_perm:[1,0,3,2] row_mask:0xf bank_mask:0xf
    s_nop 1
    v_max_f32_dpp v30, v30, v30 quad_perm:[2,3,0,1] row_mask:0xf bank_mask:0xf
    s_nop 1
    v_max_f32_dpp v30, v30, v30 row_half_mirror row_mask:0xf bank_mask:0xf
    v_sub_f32 v28, v28, v30
    v_sub_f32 v26, v26, v30
    v_mul_f32 v28, 0x3fb8aa3b, v28
    v_mul_f32 v26, 0x3fb8aa3b, v26
    v_exp_f32 v28, v28
    v_exp_f32 v26, v26
    v_mul_f32 v29, v28, v29
    s_nop 1
    v_add_f32_dpp v29, v29, v29 quad_perm:[1,0,3,2] row_mask:0xf bank_mask:0xf
    s_nop 1
    v_add_f32_dpp v29, v29, v29 quad_perm:[2,3,0,1] row_mask:0xf bank_mask:0xf
    s_nop 1
    v_add_f32_dpp v29, v29, v29 row_half_mirror row_mask:0xf bank_mask:0xf
    v_rcp_f32 v29, v29
    s_nop 0
    v_mul_f32 v26, v26, v29
    s_nop 0
    v_readlane_b32 s74, v26, 0
    v_readlane_b32 s75, v26, 1
    v_readlane_b32 s76, v26, 2
    v_readlane_b32 s77, v26, 3
    s_cmp_lg_u32 s36, 0
    s_cbranch_scc1 L_noY
    s_add_u32 s48, s73, 524288
    s_add_u32 s49, s48, 4096
    s_add_u32 s56, s48, 16384
    s_add_u32 s57, s48, 24576
    s_mov_b32 s70, 2097152
L_pollY:
    s_sleep 4
    buffer_load_dwordx4 v[160:163], v59, s[40:43], s48 offen sc1
    buffer_load_dwordx4 v[164:167], v59, s[40:43], s49 offen sc1
    s_sub_u32 s70, s70, 1
    s_cbranch_scc1 L_pollY_done
    s_waitcnt vmcnt(0)
    v_bitop3_b32 v24, v160, v161, v61 bitop3:0x7e
    v_bitop3_b32 v25, v162, v163, v61 bitop3:0x7e
    v_bitop3_b32 v26, v164, v165, v61 bitop3:0x7e
    v_or3_b32 v24, v24, v25, v26
    v_bitop3_b32 v25, v166, v167, v61 bitop3:0x7e
    v_or_b32 v24, v24, v25
    v_and_b32 v24, 0x3ff, v24
    v_cmp_ne_u32 vcc, 0, v24
    s_nop 1
    s_cbranch_vccnz L_pollY
L_pollY_done:
    v_and_b32 v160, s7, v160
    v_and_b32 v161, s7, v161
    v_and_b32 v162, s7, v162
    v_and_b32 v163, s7, v163
    v_and_b32 v164, s7, v164
    v_and_b32 v165, s7, v165
    v_and_b32 v166, s7, v166
    v_and_b32 v167, s7, v167
    v_add_f32 v28, v160, v164
    v_add_f32 v29, v161, v165
    v_add_f32 v30, v162, v166
    v_add_f32 v31, v163, v167
    s_nop 0
    v_permlane32_swap_b32 v28, v30
    v_permlane32_swap_b32 v29, v31
    v_add_f32 v28, v28, v30
    v_add_f32 v29, v29, v31
    s_nop 1
    v_permlane16_swap_b32 v28, v29
    v_add_f32 v28, v28, v29
    s_nop 1
    v_add_f32_dpp v28, v28, v28 row_ror:4 row_mask:0xf bank_mask:0xf
    s_nop 1
    v_add_f32_dpp v28, v28, v28 row_ror:8 row_mask:0xf bank_mask:0xf
    v_cvt_pk_bf16_f32 v28, v28, v28
    v_and_b32 v28, 0xffff0000, v28
    v_mul_f32 v24, 0xbfb8aa3b, v28
    v_exp_f32 v24, v24
    s_nop 0
    v_add_f32 v24, 1.0, v24
    v_rcp_f32 v24, v24
    s_nop 0
    v_mul_f32 v62, v28, v24
    v_cvt_pk_bf16_f32 v62, v62, v62
    v_and_b32 v62, 0xffff0000, v62
    s_cmp_lg_u32 s2, 0
    s_cbranch_scc1 L_noY
    s_mov_b64 exec, 1
    v_mov_b32 v24, 0
    buffer_store_dword v45, v24, s[40:43], s79 offen sc1
    s_mov_b64 exec, -1
L_noY:
    s_add_u32 s48, s73, 393216
    s_xor_b32 s48, s48, s38
    s_add_u32 s49, s48, 4096
    s_add_u32 s56, s48, 16384
    s_add_u32 s57, s48, 24576
    v_mov_b32 v24, 0
    s_mov_b32 s70, 16777216
L_pollP:
    s_sleep 1
    ds_read_b32 v28, v24 offset:308
    s_sub_u32 s70, s70, 1
    s_cbranch_scc1 L_pollP_done
    s_waitcnt lgkmcnt(0)
    v_cmp_eq_u32 vcc, 0, v28
    s_nop 1
    s_cbranch_vccnz L_pollP
L_pollP_done:
    buffer_load_dwordx2 v[64:65], v58, s[24:27], s71 offen nt
    buffer_load_dwordx2 v[66:67], v58, s[24:27], s71 offen offset:1024 nt
    buffer_load_dwordx2 v[68:69], v58, s[24:27], s71 offen offset:2048 nt
    buffer_load_dwordx2 v[70:71], v58, s[24:27], s71 offen offset:3072 nt
    s_addk_i32 s71, 0x1000
    buffer_load_dwordx2 v[72:73], v58, s[24:27], s71 offen nt
    buffer_load_dwordx2 v[74:75], v58, s[24:27], s71 offen offset:1024 nt
    buffer_load_dwordx2 v[76:77], v58, s[24:27], s71 offen offset:2048 nt
    buffer_load_dwordx2 v[78:79], v58, s[24:27], s71 offen offset:3072 nt
    s_addk_i32 s71, 0x1000
    buffer_load_dwordx2 v[80:81], v58, s[24:27], s71 offen nt
    buffer_load_dwordx2 v[82:83], v58, s[24:27], s71 offen offset:1024 nt
    buffer_load_dwordx2 v[84:85], v58, s[24:27], s71 offen offset:2048 nt
    buffer_load_dwordx2 v[86:87], v58, s[24:27], s71 offen offset:3072 nt
    s_addk_i32 s71, 0x1000
    buffer_load_dwordx2 v[88:89], v58, s[24:27], s71 offen nt
    buffer_load_dwordx2 v[90:91], v58, s[24:27], s71 offen offset:1024 nt
    buffer_load_dwordx2 v[92:93], v58, s[24:27], s71 offen offset:2048 nt
    buffer_load_dwordx2 v[94:95], v58, s[24:27], s71 offen offset:3072 nt
    s_addk_i32 s71, 0x1000
    buffer_load_dwordx2 v[96:97], v58, s[24:27], s71 offen nt
    buffer_load_dwordx2 v[98:99], v58, s[24:27], s71 offen offset:1024 nt
    buffer_load_dwordx2 v[100:101], v58, s[24:27], s71 offen offset:2048 nt
    buffer_load_dwordx2 v[102:103], v58, s[24:27], s71 offen offset:3072 nt
    s_addk_i32 s71, 0x1000
    buffer_load_dwordx2 v[104:105], v58, s[24:27], s71 offen nt
    buffer_load_dwordx2 v[106:107], v58, s[24:27], s71 offen offset:1024 nt
    buffer_load_dwordx2 v[108:109], v58, s[24:27], s71 offen offset:2048 nt
    buffer_load_dwordx2 v[110:111], v58, s[24:27], s71 offen offset:3072 nt
    s_addk_i32 s71, 0x1000
    buffer_load_dwordx2 v[112:113], v58, s[24:27], s71 offen nt
    buffer_load_dwordx2 v[114:115], v58, s[24:27], s71 offen offset:1024 nt
    buffer_load_dwordx2 v[116:117], v58, s[24:27], s71 offen offset:2048 nt
    buffer_load_dwordx2 v[118:119], v58, s[24:27], s71 offen offset:3072 nt
    s_addk_i32 s71, 0x1000
    buffer_load_dwordx2 v[120:121], v58, s[24:27], s71 offen nt
    buffer_load_dwordx2 v[122:123], v58, s[24:27], s71 offen offset:1024 nt
    buffer_load_dwordx2 v[124:125], v58, s[24:27], s71 offen offset:2048 nt
    buffer_load_dwordx2 v[126:127], v58, s[24:27], s71 offen offset:3072 nt
    s_mov_b32 exec_hi, 0
    s_cmp_lg_u32 s37, 0
    s_barrier
    ds_read_b128 v[24:27], v63 offset:1024
    ds_read_b128 v[28:31], v63 offset:1536
    ds_read_b128 v[32:35], v63 offset:2048
    ds_read_b128 v[36:39], v63 offset:2560
    s_waitcnt lgkmcnt(3)
    v_pk_mul_f32 v[16:17], v[24:25], s[74:75] op_sel_hi:[1,0]
    v_pk_mul_f32 v[18:19], v[26:27], s[74:75] op_sel_hi:[1,0]
    s_waitcnt lgkmcnt(2)
    v_pk_fma_f32 v[16:17], v[28:29], s[74:75], v[16:17] op_sel:[0,1,0] op_sel_hi:[1,1,1]
    v_pk_fma_f32 v[18:19], v[30:31], s[74:75], v[18:19] op_sel:[0,1,0] op_sel_hi:[1,1,1]
    s_waitcnt lgkmcnt(1)
    v_pk_fma_f32 v[16:17], v[32:33], s[76:77], v[16:17] op_sel_hi:[1,0,1]
    v_pk_fma_f32 v[18:19], v[34:35], s[76:77], v[18:19] op_sel_hi:[1,0,1]
    s_waitcnt lgkmcnt(0)
    v_pk_fma_f32 v[16:17], v[36:37], s[76:77], v[16:17] op_sel:[0,1,0] op_sel_hi:[1,1,1]
    v_pk_fma_f32 v[18:19], v[38:39], s[76:77], v[18:19] op_sel:[0,1,0] op_sel_hi:[1,1,1]
    v_and_or_b32 v16, v16, s7, v61
    v_and_or_b32 v17, v17, s7, v61
    v_and_or_b32 v18, v18, s7, v61
    v_and_or_b32 v19, v19, s7, v61
    s_cbranch_scc1 L_far
    buffer_store_dwordx4 v[16:19], v63, s[40:43], s63 offen
    s_branch L_near
L_far:
    buffer_store_dwordx4 v[16:19], v63, s[40:43], s63 offen sc1
L_near:
    s_mov_b64 exec, -1
    s_mov_b32 s70, 2097152
L_pollO:
    buffer_load_dwordx2 v[160:161], v60, s[40:43], s78 offen sc1
    buffer_load_dwordx2 v[162:163], v60, s[40:43], s78 offen offset:512 sc1
    buffer_load_dwordx2 v[164:165], v60, s[40:43], s78 offen offset:1024 sc1
    buffer_load_dwordx2 v[166:167], v60, s[40:43], s78 offen offset:1536 sc1
    buffer_load_dwordx2 v[168:169], v60, s[40:43], s78 offen offset:2048 sc1
    buffer_load_dwordx2 v[170:171], v60, s[40:43], s78 offen offset:2560 sc1
    buffer_load_dwordx2 v[172:173], v60, s[40:43], s78 offen offset:3072 sc1
    buffer_load_dwordx2 v[174:175], v60, s[40:43], s78 offen offset:3584 sc1
    s_sub_u32 s70, s70, 1
    s_cbranch_scc1 L_pollO_ok0
    s_waitcnt vmcnt(0)
    v_lshl_add_u64 v[160:161], v[160:161], 0, s[14:15]
    v_lshl_add_u64 v[162:163], v[162:163], 0, s[14:15]
    v_lshl_add_u64 v[164:165], v[164:165], 0, s[14:15]
    v_lshl_add_u64 v[166:167], v[166:167], 0, s[14:15]
    v_lshl_add_u64 v[168:169], v[168:169], 0, s[14:15]
    v_lshl_add_u64 v[170:171], v[170:171], 0, s[14:15]
    v_lshl_add_u64 v[172:173], v[172:173], 0, s[14:15]
    v_lshl_add_u64 v[174:175], v[174:175], 0, s[14:15]
    v_or3_b32 v24, v160, v161, v162
    v_or3_b32 v25, v163, v164, v165
    v_or3_b32 v24, v24, v166, v167
    v_or3_b32 v25, v25, v168, v169
    v_or3_b32 v24, v24, v170, v171
    v_or3_b32 v25, v25, v172, v173
    v_or3_b32 v24, v24, v174, v175
    v_bitop3_b32 v24, v24, v25, s7 bitop3:0x54
    v_cmp_ne_u32 vcc, 0, v24
    s_nop 1
    s_cbranch_vccnz L_pollO
L_pollO_ok0:
    v_pk_add_f32 v[160:161], v[160:161], v[162:163]
    v_pk_add_f32 v[164:165], v[164:165], v[166:167]
    v_pk_add_f32 v[168:169], v[168:169], v[170:171]
    v_pk_add_f32 v[172:173], v[172:173], v[174:175]
    v_pk_add_f32 v[160:161], v[160:161], v[164:165]
    v_pk_add_f32 v[168:169], v[168:169], v[172:173]
    v_pk_add_f32 v[26:27], v[160:161], v[168:169]
L_pollO_done:
    v_cvt_pk_bf16_f32 v3, v26, v26
    v_cvt_pk_bf16_f32 v54, v27, v27
    s_nop 0
    v_and_b32_dpp v8, v3, v53 row_newbcast:0 row_mask:0xf bank_mask:0xf
    v_and_b32_dpp v9, v3, v55 row_newbcast:0 row_mask:0xf bank_mask:0xf
    v_and_b32_dpp v10, v54, v53 row_newbcast:0 row_mask:0xf bank_mask:0xf
    v_and_b32_dpp v11, v54, v55 row_newbcast:0 row_mask:0xf bank_mask:0xf
    v_and_b32_dpp v12, v3, v53 row_newbcast:1 row_mask:0xf bank_mask:0xf
    v_and_b32_dpp v13, v3, v55 row_newbcast:1 row_mask:0xf bank_mask:0xf
    v_and_b32_dpp v14, v54, v53 row_newbcast:1 row_mask:0xf bank_mask:0xf
    v_and_b32_dpp v15, v54, v55 row_newbcast:1 row_mask:0xf bank_mask:0xf
    v_mfma_f32_16x16x32_bf16 v[16:19], v[8:11], v[64:67], 0
    v_and_b32_dpp v8, v3, v53 row_newbcast:2 row_mask:0xf bank_mask:0xf
    v_and_b32_dpp v9, v3, v55 row_newbcast:2 row_mask:0xf bank_mask:0xf
    v_and_b32_dpp v10, v54, v53 row_newbcast:2 row_mask:0xf bank_mask:0xf
    v_and_b32_dpp v11, v54, v55 row_newbcast:2 row_mask:0xf bank_mask:0xf
    v_mfma_f32_16x16x32_bf16 v[16:19], v[12:15], v[68:71], v[16:19]
    v_and_b32_dpp v12, v3, v53 row_newbcast:3 row_mask:0xf bank_mask:0xf
    v_and_b32_dpp v13, v3, v55 row_newbcast:3 row_mask:0xf bank_mask:0xf
    v_and_b32_dpp v14, v54, v53 row_newbcast:3 row_mask:0xf bank_mask:0xf
    v_and_b32_dpp v15, v54, v55 row_newbcast:3 row_mask:0xf bank_mask:0xf
    v_mfma_f32_16x16x32_bf16 v[16:19], v[8:11], v[72:75], v[16:19]
    v_and_b32_dpp v8, v3, v53 row_newbcast:4 row_mask:0xf bank_mask:0xf
    v_and_b32_dpp v9, v3, v55 row_newbcast:4 row_mask:0xf bank_mask:0xf
    v_and_b32_dpp v10, v54, v53 row_newbcast:4 row_mask:0xf bank_mask:0xf
    v_and_b32_dpp v11, v54, v55 row_newbcast:4 row_mask:0xf bank_mask:0xf
    v_mfma_f32_16x16x32_bf16 v[16:19], v[12:15], v[76:79], v[16:19]
    v_and_b32_dpp v12, v3, v53 row_newbcast:5 row_mask:0xf bank_mask:0xf
    v_and_b32_dpp v13, v3, v55 row_newbcast:5 row_mask:0xf bank_mask:0xf
    v_and_b32_dpp v14, v54, v53 row_newbcast:5 row_mask:0xf bank_mask:0xf
    v_and_b32_dpp v15, v54, v55 row_newbcast:5 row_mask:0xf bank_mask:0xf
    v_mfma_f32_16x16x32_bf16 v[16:19], v[8:11], v[80:83], v[16:19]
    v_and_b32_dpp v8, v3, v53 row_newbcast:6 row_mask:0xf bank_mask:0xf
    v_and_b32_dpp v9, v3, v55 row_newbcast:6 row_mask:0xf bank_mask:0xf
    v_and_b32_dpp v10, v54, v53 row_newbcast:6 row_mask:0xf bank_mask:0xf
    v_and_b32_dpp v11, v54, v55 row_newbcast:6 row_mask:0xf bank_mask:0xf
    v_mfma_f32_16x16x32_bf16 v[16:19], v[12:15], v[84:87], v[16:19]
    v_and_b32_dpp v12, v3, v53 row_newbcast:7 row_mask:0xf bank_mask:0xf
    v_and_b32_dpp v13, v3, v55 row_newbcast:7 row_mask:0xf bank_mask:0xf
    v_and_b32_dpp v14, v54, v53 row_newbcast:7 row_mask:0xf bank_mask:0xf
    v_and_b32_dpp v15, v54, v55 row_newbcast:7 row_mask:0xf bank_mask:0xf
    v_mfma_f32_16x16x32_bf16 v[16:19], v[8:11], v[88:91], v[16:19]
    v_and_b32_dpp v8, v3, v53 row_newbcast:8 row_mask:0xf bank_mask:0xf
    v_and_b32_dpp v9, v3, v55 row_newbcast:8 row_mask:0xf bank_mask:0xf
    v_and_b32_dpp v10, v54, v53 row_newbcast:8 row_mask:0xf bank_mask:0xf
    v_and_b32_dpp v11, v54, v55 row_newbcast:8 row_mask:0xf bank_mask:0xf
    v_mfma_f32_16x16x32_bf16 v[16:19], v[12:15], v[92:95], v[16:19]
    v_and_b32_dpp v12, v3, v53 row_newbcast:9 row_mask:0xf bank_mask:0xf
    v_and_b32_dpp v13, v3, v55 row_newbcast:9 row_mask:0xf bank_mask:0xf
    v_and_b32_dpp v14, v54, v53 row_newbcast:9 row_mask:0xf bank_mask:0xf
    v_and_b32_dpp v15, v54, v55 row_newbcast:9 row_mask:0xf bank_mask:0xf
    v_mfma_f32_16x16x32_bf16 v[16:19], v[8:11], v[96:99], v[16:19]
    v_and_b32_dpp v8, v3, v53 row_newbcast:10 row_mask:0xf bank_mask:0xf
    v_and_b32_dpp v9, v3, v55 row_newbcast:10 row_mask:0xf bank_mask:0xf
    v_and_b32_dpp v10, v54, v53 row_newbcast:10 row_mask:0xf bank_mask:0xf
    v_and_b32_dpp v11, v54, v55 row_newbcast:10 row_mask:0xf bank_mask:0xf
    v_mfma_f32_16x16x32_bf16 v[16:19], v[12:15], v[100:103], v[16:19]
    v_and_b32_dpp v12, v3, v53 row_newbcast:11 row_mask:0xf bank_mask:0xf
    v_and_b32_dpp v13, v3, v55 row_newbcast:11 row_mask:0xf bank_mask:0xf
    v_and_b32_dpp v14, v54, v53 row_newbcast:11 row_mask:0xf bank_mask:0xf
    v_and_b32_dpp v15, v54, v55 row_newbcast:11 row_mask:0xf bank_mask:0xf
    v_mfma_f32_16x16x32_bf16 v[16:19], v[8:11], v[104:107], v[16:19]
    v_and_b32_dpp v8, v3, v53 row_newbcast:12 row_mask:0xf bank_mask:0xf
    v_and_b32_dpp v9, v3, v55 row_newbcast:12 row_mask:0xf bank_mask:0xf
    v_and_b32_dpp v10, v54, v53 row_newbcast:12 row_mask:0xf bank_mask:0xf
    v_and_b32_dpp v11, v54, v55 row_newbcast:12 row_mask:0xf bank_mask:0xf
    v_mfma_f32_16x16x32_bf16 v[16:19], v[12:15], v[108:111], v[16:19]
    v_and_b32_dpp v12, v3, v53 row_newbcast:13 row_mask:0xf bank_mask:0xf
    v_and_b32_dpp v13, v3, v55 row_newbcast:13 row_mask:0xf bank_mask:0xf
    v_and_b32_dpp v14, v54, v53 row_newbcast:13 row_mask:0xf bank_mask:0xf
    v_and_b32_dpp v15, v54, v55 row_newbcast:13 row_mask:0xf bank_mask:0xf
    v_mfma_f32_16x16x32_bf16 v[16:19], v[8:11], v[112:115], v[16:19]
    v_and_b32_dpp v8, v3, v53 row_newbcast:14 row_mask:0xf bank_mask:0xf
    v_and_b32_dpp v9, v3, v55 row_newbcast:14 row_mask:0xf bank_mask:0xf
    v_and_b32_dpp v10, v54, v53 row_newbcast:14 row_mask:0xf bank_mask:0xf
    v_and_b32_dpp v11, v54, v55 row_newbcast:14 row_mask:0xf bank_mask:0xf
    v_mfma_f32_16x16x32_bf16 v[16:19], v[12:15], v[116:119], v[16:19]
    v_and_b32_dpp v12, v3, v53 row_newbcast:15 row_mask:0xf bank_mask:0xf
    v_and_b32_dpp v13, v3, v55 row_newbcast:15 row_mask:0xf bank_mask:0xf
    v_and_b32_dpp v14, v54, v53 row_newbcast:15 row_mask:0xf bank_mask:0xf
    v_and_b32_dpp v15, v54, v55 row_newbcast:15 row_mask:0xf bank_mask:0xf
    v_mfma_f32_16x16x32_bf16 v[16:19], v[8:11], v[120:123], v[16:19]
    s_nop 0
    v_mfma_f32_16x16x32_bf16 v[16:19], v[12:15], v[124:127], v[16:19]
    s_mov_b64 exec, 0xffff
    s_nop 6
    v_and_or_b32 v32, v16, s7, v61
    v_and_or_b32 v33, v17, s7, v61
    v_and_or_b32 v34, v18, s7, v61
    v_and_or_b32 v35, v19, s7, v61
    buffer_store_dwordx4 v[32:35], v63, s[40:43], s64 offen sc1
    s_mov_b64 exec, -1
    s_cmp_lg_u32 s36, 0
    s_cbranch_scc1 L_sdone
    s_mov_b32 s70, 2097152
    buffer_load_dwordx4 v[64:67], v59, s[40:43], s48 offen sc1
    buffer_load_dwordx4 v[68:71], v59, s[40:43], s49 offen sc1
    s_sleep 2
    buffer_load_dwordx4 v[72:75], v59, s[40:43], s48 offen sc1
    buffer_load_dwordx4 v[76:79], v59, s[40:43], s49 offen sc1
    s_sleep 2
L_pollS:
    buffer_load_dwordx4 v[80:83], v59, s[40:43], s48 offen sc1
    buffer_load_dwordx4 v[84:87], v59, s[40:43], s49 offen sc1
    s_sub_u32 s70, s70, 1
    s_cbranch_scc1 L_pollS_ok0
    s_waitcnt vmcnt(4)
    v_lshl_add_u64 v[64:65], v[64:65], 0, s[14:15]
    v_lshl_add_u64 v[66:67], v[66:67], 0, s[14:15]
    v_lshl_add_u64 v[68:69], v[68:69], 0, s[14:15]
    v_lshl_add_u64 v[70:71], v[70:71], 0, s[14:15]
    v_or3_b32 v24, v64, v65, v66
    v_or3_b32 v25, v67, v68, v69
    v_or3_b32 v24, v24, v70, v71
    v_bitop3_b32 v24, v24, v25, s7 bitop3:0x54
    v_cmp_ne_u32 vcc, 0, v24
    s_nop 1
    s_cbranch_vccz L_pollS_ok0
    buffer_load_dwordx4 v[64:67], v59, s[40:43], s48 offen sc1
    buffer_load_dwordx4 v[68:71], v59, s[40:43], s49 offen sc1
    s_waitcnt vmcnt(4)
    v_lshl_add_u64 v[72:73], v[72:73], 0, s[14:15]
    v_lshl_add_u64 v[74:75], v[74:75], 0, s[14:15]
    v_lshl_add_u64 v[76:77], v[76:77], 0, s[14:15]
    v_lshl_add_u64 v[78:79], v[78:79], 0, s[14:15]
    v_or3_b32 v24, v72, v73, v74
    v_or3_b32 v25, v75, v76, v77
    v_or3_b32 v24, v24, v78, v79
    v_bitop3_b32 v24, v24, v25, s7 bitop3:0x54
    v_cmp_ne_u32 vcc, 0, v24
    s_nop 1
    s_cbranch_vccz L_pollS_ok1
    buffer_load_dwordx4 v[72:75], v59, s[40:43], s48 offen sc1
    buffer_load_dwordx4 v[76:79], v59, s[40:43], s49 offen sc1
    s_waitcnt vmcnt(4)
    v_lshl_add_u64 v[80:81], v[80:81], 0, s[14:15]
    v_lshl_add_u64 v[82:83], v[82:83], 0, s[14:15]
    v_lshl_add_u64 v[84:85], v[84:85], 0, s[14:15]
    v_lshl_add_u64 v[86:87], v[86:87], 0, s[14:15]
    v_or3_b32 v24, v80, v81, v82
    v_or3_b32 v25, v83, v84, v85
    v_or3_b32 v24, v24, v86, v87
    v_bitop3_b32 v24, v24, v25, s7 bitop3:0x54
    v_cmp_ne_u32 vcc, 0, v24
    s_nop 1
    s_cbranch_vccnz L_pollS
L_pollS_ok2:
    v_pk_add_f32 v[28:29], v[80:81], v[84:85]
    v_pk_add_f32 v[30:31], v[82:83], v[86:87]
    s_branch L_pollS_done
L_pollS_ok1:
    v_pk_add_f32 v[28:29], v[72:73], v[76:77]
    v_pk_add_f32 v[30:31], v[74:75], v[78:79]
    s_branch L_pollS_done
L_pollS_ok0:
    v_pk_add_f32 v[28:29], v[64:65], v[68:69]
    v_pk_add_f32 v[30:31], v[66:67], v[70:71]
L_pollS_done:
    s_nop 1
    v_permlane32_swap_b32 v28, v30
    v_permlane32_swap_b32 v29, v31
    v_add_f32 v28, v28, v30
    v_add_f32 v29, v29, v31
    s_nop 1
    v_permlane16_swap_b32 v28, v29
    v_add_f32 v28, v28, v29
    s_nop 1
    v_add_f32_dpp v28, v28, v28 row_ror:4 row_mask:0xf bank_mask:0xf
    s_nop 1
    v_add_f32_dpp v28, v28, v28 row_ror:8 row_mask:0xf bank_mask:0xf
    v_cvt_pk_bf16_f32 v28, v28, v28
    v_and_b32 v28, 0xffff0000, v28
    v_mul_f32 v28, v28, v62
    v_cvt_pk_bf16_f32 v28, v28, v28
    v_and_b32 v28, 0xffff0000, v28
    v_add_f32 v28, v28, v51
    v_cvt_pk_bf16_f32 v28, v28, v28
    s_mov_b32 exec_lo, 0x000f000f
    s_mov_b32 exec_hi, 0x000f000f
    buffer_store_short v28, v49, s[32:35], 0 offen
L_sdone:
L_end:
    s_endpgm
L_stream:
    v_and_b32 v42, 1, v0
    v_lshlrev_b32 v42, 4, v42
    v_lshlrev_b32 v42, v42, s50
    v_bfe_u32 v43, v0, 1, 2
    v_cmp_eq_u32 s[84:85], 0, v43
    v_cmp_eq_u32 s[86:87], 1, v43
    v_cmp_eq_u32 s[88:89], 2, v43
    v_cmp_eq_u32 s[90:91], 3, v43
    v_cndmask_b32 v2, 0, v42, s[84:85]
    v_cndmask_b32 v3, 0, v42, s[86:87]
    v_cndmask_b32 v4, 0, v42, s[88:89]
    v_cndmask_b32 v5, 0, v42, s[90:91]
    s_mov_b32 s52, 0xcccccccc
    s_mov_b32 s53, 0xcccccccc
    s_mov_b32 s54, 0xaaaaaaaa
    s_mov_b32 s55, 0xaaaaaaaa
    v_and_b32 v44, 15, v0
    v_lshlrev_b32 v44, 4, v44
    v_mov_b32 v46, s3
    v_lshlrev_b32 v46, 2, v46
    v_mov_b32 v47, 1
    s_mov_b32 s58, 0
    v_mov_b32 v241, 0
    s_and_b32 vcc_lo, s58, 2
    s_mov_b32 vcc_hi, 0
    s_barrier
    s_addk_i32 s49, 0x4000
    buffer_load_dwordx4 v[64:67], v1, s[8:11], s49 offen nt
    s_cbranch_vccnz L_c5
    s_waitcnt vmcnt(4)
L_c5:
    buffer_load_dwordx4 v[68:71], v1, s[8:11], s49 offen offset:1024 nt
    s_cbranch_vccnz L_c6
    s_waitcnt vmcnt(4)
L_c6:
    buffer_load_dwordx4 v[72:75], v1, s[8:11], s49 offen offset:2048 nt
    s_waitcnt vmcnt(6)
    s_cbranch_vccnz L_c7
    s_waitcnt vmcnt(4)
L_c7:
    buffer_load_dwordx4 v[76:79], v1, s[8:11], s49 offen offset:3072 nt
    s_addk_i32 s49, 0x4000
    s_waitcnt vmcnt(6)
    s_cbranch_vccnz L_c8
    s_waitcnt vmcnt(4)
L_c8:
    buffer_load_dwordx4 v[80:83], v1, s[8:11], s49 offen nt
    s_waitcnt vmcnt(6)
    s_cbranch_vccnz L_c9
    s_waitcnt vmcnt(4)
L_c9:
    buffer_load_dwordx4 v[84:87], v1, s[8:11], s49 offen offset:1024 nt
    s_waitcnt vmcnt(6)
    s_cbranch_vccnz L_c10
    s_waitcnt vmcnt(4)
L_c10:
    buffer_load_dwordx4 v[88:91], v1, s[8:11], s49 offen offset:2048 nt
    s_waitcnt vmcnt(6)
    s_cbranch_vccnz L_c11
    s_waitcnt vmcnt(4)
L_c11:
    buffer_load_dwordx4 v[92:95], v1, s[8:11], s49 offen offset:3072 nt
    s_addk_i32 s49, 0x4000
    s_waitcnt vmcnt(6)
    s_cbranch_vccnz L_c12
    s_waitcnt vmcnt(4)
L_c12:
    buffer_load_dwordx4 v[96:99], v1, s[8:11], s49 offen nt
    s_waitcnt vmcnt(6)
    s_cbranch_vccnz L_c13
    s_waitcnt vmcnt(4)
L_c13:
    buffer_load_dwordx4 v[100:103], v1, s[8:11], s49 offen offset:1024 nt
    s_waitcnt vmcnt(6)
    s_cbranch_vccnz L_c14
    s_waitcnt vmcnt(4)
L_c14:
    buffer_load_dwordx4 v[104:107], v1, s[8:11], s49 offen offset:2048 nt
    s_waitcnt vmcnt(6)
    s_cbranch_vccnz L_c15
    s_waitcnt vmcnt(4)
L_c15:
    buffer_load_dwordx4 v[108:111], v1, s[8:11], s49 offen offset:3072 nt
    s_addk_i32 s49, 0x4000
    ds_write_b32 v46, v47 offset:288
    v_add_u32 v47, 1, v47
    ds_read_b32 v240, v241 offset:316
    s_waitcnt vmcnt(6)
    s_cbranch_vccnz L_c16
    s_waitcnt vmcnt(4)
L_c16:
    buffer_load_dwordx4 v[112:115], v1, s[8:11], s49 offen nt
    s_waitcnt lgkmcnt(0)
    v_readfirstlane_b32 s58, v240
    s_nop 0
    s_and_b32 vcc_lo, s58, 2
    s_waitcnt vmcnt(6)
    s_cbranch_vccnz L_c17
    s_waitcnt vmcnt(4)
L_c17:
    buffer_load_dwordx4 v[116:119], v1, s[8:11], s49 offen offset:1024 nt
    s_waitcnt vmcnt(6)
    s_cbranch_vccnz L_c18
    s_waitcnt vmcnt(4)
L_c18:
    buffer_load_dwordx4 v[120:123], v1, s[8:11], s49 offen offset:2048 nt
    s_waitcnt vmcnt(6)
    s_cbranch_vccnz L_c19
    s_waitcnt vmcnt(4)
L_c19:
    buffer_load_dwordx4 v[124:127], v1, s[8:11], s49 offen offset:3072 nt
    s_addk_i32 s49, 0x4000
    ds_write_b32 v46, v47 offset:288
    v_add_u32 v47, 1, v47
    ds_read_b32 v240, v241 offset:316
    s_waitcnt vmcnt(6)
    s_cbranch_vccnz L_c20
    s_waitcnt vmcnt(4)
L_c20:
    buffer_load_dwordx4 v[128:131], v1, s[8:11], s49 offen nt
    s_waitcnt lgkmcnt(0)
    v_readfirstlane_b32 s58, v240
    s_nop 0
    s_and_b32 vcc_lo, s58, 2
    s_waitcnt vmcnt(6)
    s_cbranch_vccnz L_c21
    s_waitcnt vmcnt(4)
L_c21:
    buffer_load_dwordx4 v[132:135], v1, s[8:11], s49 offen offset:1024 nt
    s_waitcnt vmcnt(6)
    s_cbranch_vccnz L_c22
    s_waitcnt vmcnt(4)
L_c22:
    buffer_load_dwordx4 v[136:139], v1, s[8:11], s49 offen offset:2048 nt
    s_waitcnt vmcnt(6)
    s_cbranch_vccnz L_c23
    s_waitcnt vmcnt(4)
L_c23:
    buffer_load_dwordx4 v[140:143], v1, s[8:11], s49 offen offset:3072 nt
    s_addk_i32 s49, 0x4000
    ds_write_b32 v46, v47 offset:288
    v_add_u32 v47, 1, v47
    ds_read_b32 v240, v241 offset:316
    s_waitcnt vmcnt(6)
    s_cbranch_vccnz L_c24
    s_waitcnt vmcnt(4)
L_c24:
    buffer_load_dwordx4 v[144:147], v1, s[8:11], s49 offen nt
    s_waitcnt lgkmcnt(0)
    v_readfirstlane_b32 s58, v240
    s_nop 0
    s_and_b32 vcc_lo, s58, 2
    s_waitcnt vmcnt(6)
    s_cbranch_vccnz L_c25
    s_waitcnt vmcnt(4)
L_c25:
    buffer_load_dwordx4 v[148:151], v1, s[8:11], s49 offen offset:1024 nt
    s_waitcnt vmcnt(6)
    s_cbranch_vccnz L_c26
    s_waitcnt vmcnt(4)
L_c26:
    buffer_load_dwordx4 v[152:155], v1, s[8:11], s49 offen offset:2048 nt
    s_waitcnt vmcnt(6)
    s_cbranch_vccnz L_c27
    s_waitcnt vmcnt(4)
L_c27:
    buffer_load_dwordx4 v[156:159], v1, s[8:11], s49 offen offset:3072 nt
    s_addk_i32 s49, 0x4000
    ds_write_b32 v46, v47 offset:288
    v_add_u32 v47, 1, v47
    ds_read_b32 v240, v241 offset:316
    s_waitcnt vmcnt(6)
    s_cbranch_vccnz L_c28
    s_waitcnt vmcnt(4)
L_c28:
    buffer_load_dwordx4 v[160:163], v1, s[8:11], s49 offen nt
    s_waitcnt lgkmcnt(0)
    v_readfirstlane_b32 s58, v240
    s_nop 0
    s_and_b32 vcc_lo, s58, 2
    s_waitcnt vmcnt(6)
    s_cbranch_vccnz L_c29
    s_waitcnt vmcnt(4)
L_c29:
    buffer_load_dwordx4 v[164:167], v1, s[8:11], s49 offen offset:1024 nt
    s_waitcnt vmcnt(6)
    s_cbranch_vccnz L_c30
    s_waitcnt vmcnt(4)
L_c30:
    buffer_load_dwordx4 v[168:171], v1, s[8:11], s49 offen offset:2048 nt
    s_waitcnt vmcnt(6)
    s_cbranch_vccnz L_c31
    s_waitcnt vmcnt(4)
L_c31:
    buffer_load_dwordx4 v[172:175], v1, s[8:11], s49 offen offset:3072 nt
    s_addk_i32 s49, 0x4000
    ds_write_b32 v46, v47 offset:288
    v_add_u32 v47, 1, v47
    ds_read_b32 v240, v241 offset:316
    s_waitcnt vmcnt(6)
    s_cbranch_vccnz L_c32
    s_waitcnt vmcnt(4)
L_c32:
    buffer_load_dwordx4 v[176:179], v1, s[8:11], s49 offen nt
    s_waitcnt lgkmcnt(0)
    v_readfirstlane_b32 s58, v240
    s_nop 0
    s_and_b32 vcc_lo, s58, 2
    s_waitcnt vmcnt(6)
    s_cbranch_vccnz L_c33
    s_waitcnt vmcnt(4)
L_c33:
    buffer_load_dwordx4 v[180:183], v1, s[8:11], s49 offen offset:1024 nt
    s_waitcnt vmcnt(6)
    s_cbranch_vccnz L_c34
    s_waitcnt vmcnt(4)
L_c34:
    buffer_load_dwordx4 v[184:187], v1, s[8:11], s49 offen offset:2048 nt
    s_waitcnt vmcnt(6)
    s_cbranch_vccnz L_c35
    s_waitcnt vmcnt(4)
L_c35:
    buffer_load_dwordx4 v[188:191], v1, s[8:11], s49 offen offset:3072 nt
    s_addk_i32 s49, 0x4000
    ds_write_b32 v46, v47 offset:288
    v_add_u32 v47, 1, v47
    ds_read_b32 v240, v241 offset:316
    s_waitcnt vmcnt(6)
    s_cbranch_vccnz L_c36
    s_waitcnt vmcnt(4)
L_c36:
    buffer_load_dwordx4 v[192:195], v1, s[8:11], s49 offen nt
    s_waitcnt lgkmcnt(0)
    v_readfirstlane_b32 s58, v240
    s_nop 0
    s_and_b32 vcc_lo, s58, 2
    s_waitcnt vmcnt(6)
    s_cbranch_vccnz L_c37
    s_waitcnt vmcnt(4)
L_c37:
    buffer_load_dwordx4 v[196:199], v1, s[8:11], s49 offen offset:1024 nt
    s_waitcnt vmcnt(6)
    s_cbranch_vccnz L_c38
    s_waitcnt vmcnt(4)
L_c38:
    buffer_load_dwordx4 v[200:203], v1, s[8:11], s49 offen offset:2048 nt
    s_waitcnt vmcnt(6)
    s_cbranch_vccnz L_c39
    s_waitcnt vmcnt(4)
L_c39:
    buffer_load_dwordx4 v[204:207], v1, s[8:11], s49 offen offset:3072 nt
    s_addk_i32 s49, 0x4000
    ds_write_b32 v46, v47 offset:288
    v_add_u32 v47, 1, v47
    ds_read_b32 v240, v241 offset:316
    s_waitcnt vmcnt(6)
    s_cbranch_vccnz L_c40
    s_waitcnt vmcnt(4)
L_c40:
    buffer_load_dwordx4 v[208:211], v1, s[8:11], s49 offen nt
    s_waitcnt lgkmcnt(0)
    v_readfirstlane_b32 s58, v240
    s_nop 0
    s_and_b32 vcc_lo, s58, 2
    s_waitcnt vmcnt(6)
    s_cbranch_vccnz L_c41
    s_waitcnt vmcnt(4)
L_c41:
    buffer_load_dwordx4 v[212:215], v1, s[8:11], s49 offen offset:1024 nt
    s_waitcnt vmcnt(6)
    s_cbranch_vccnz L_c42
    s_waitcnt vmcnt(4)
L_c42:
    buffer_load_dwordx4 v[216:219], v1, s[8:11], s49 offen offset:2048 nt
    s_waitcnt vmcnt(6)
    s_cbranch_vccnz L_c43
    s_waitcnt vmcnt(4)
L_c43:
    buffer_load_dwordx4 v[220:223], v1, s[8:11], s49 offen offset:3072 nt
    s_addk_i32 s49, 0x4000
    ds_write_b32 v46, v47 offset:288
    v_add_u32 v47, 1, v47
    ds_read_b32 v240, v241 offset:316
    s_waitcnt vmcnt(6)
    s_cbranch_vccnz L_c44
    s_waitcnt vmcnt(4)
L_c44:
    buffer_load_dwordx4 v[224:227], v1, s[8:11], s49 offen nt
    s_waitcnt lgkmcnt(0)
    v_readfirstlane_b32 s58, v240
    s_nop 0
    s_and_b32 vcc_lo, s58, 2
    s_waitcnt vmcnt(6)
    s_cbranch_vccnz L_c45
    s_waitcnt vmcnt(4)
L_c45:
    buffer_load_dwordx4 v[228:231], v1, s[8:11], s49 offen offset:1024 nt
    s_waitcnt vmcnt(6)
    s_cbranch_vccnz L_c46
    s_waitcnt vmcnt(4)
L_c46:
    buffer_load_dwordx4 v[232:235], v1, s[8:11], s49 offen offset:2048 nt
    s_waitcnt vmcnt(6)
    s_cbranch_vccnz L_c47
    s_waitcnt vmcnt(4)
L_c47:
    buffer_load_dwordx4 v[236:239], v1, s[8:11], s49 offen offset:3072 nt
    v_mov_b32 v43, 0
    s_mov_b32 s57, 16777216
L_pollQ:
    ds_read_b32 v42, v43 offset:304
    ds_read_b128 v[6:9], v44 offset:0
    s_sub_u32 s57, s57, 1
    s_cbranch_scc1 L_pollQ_done
    s_waitcnt lgkmcnt(0)
    v_cmp_eq_u32 vcc, 0, v42
    s_nop 1
    s_cbranch_vccnz L_pollQ
L_pollQ_done:
    s_and_b32 vcc_lo, s58, 2
    s_mov_b32 vcc_hi, 0
    v_mov_b32 v26, 0
    v_dot2c_f32_bf16 v26, v48, v6
    v_dot2c_f32_bf16 v26, v49, v7
    v_dot2c_f32_bf16 v26, v50, v8
    v_dot2c_f32_bf16 v26, v51, v9
    s_addk_i32 s49, 0x4000
    ds_write_b32 v46, v47 offset:288
    v_add_u32 v47, 1, v47
    ds_read_b32 v240, v241 offset:316
    s_waitcnt vmcnt(6)
    s_cbranch_vccnz L_c48
    s_waitcnt vmcnt(4)
L_c48:
    buffer_load_dwordx4 v[48:51], v1, s[8:11], s49 offen nt
    v_mov_b32 v27, 0
    v_dot2c_f32_bf16 v27, v52, v6
    v_dot2c_f32_bf16 v27, v53, v7
    v_dot2c_f32_bf16 v27, v54, v8
    v_dot2c_f32_bf16 v27, v55, v9
    s_waitcnt lgkmcnt(0)
    v_readfirstlane_b32 s58, v240
    s_nop 0
    s_and_b32 vcc_lo, s58, 2
    s_waitcnt vmcnt(6)
    s_cbranch_vccnz L_c49
    s_waitcnt vmcnt(4)
L_c49:
    buffer_load_dwordx4 v[52:55], v1, s[8:11], s49 offen offset:1024 nt
    v_mov_b32 v28, 0
    v_dot2c_f32_bf16 v28, v56, v6
    v_dot2c_f32_bf16 v28, v57, v7
    v_dot2c_f32_bf16 v28, v58, v8
    v_dot2c_f32_bf16 v28, v59, v9
    s_waitcnt vmcnt(6)
    s_cbranch_vccnz L_c50
    s_waitcnt vmcnt(4)
L_c50:
    buffer_load_dwordx4 v[56:59], v1, s[8:11], s49 offen offset:2048 nt
    v_mov_b32 v29, 0
    v_dot2c_f32_bf16 v29, v60, v6
    v_dot2c_f32_bf16 v29, v61, v7
    v_dot2c_f32_bf16 v29, v62, v8
    v_dot2c_f32_bf16 v29, v63, v9
    s_waitcnt vmcnt(6)
    s_cbranch_vccnz L_c51
    s_waitcnt vmcnt(4)
L_c51:
    buffer_load_dwordx4 v[60:63], v1, s[8:11], s49 offen offset:3072 nt
    v_mov_b32 v30, 0
    v_dot2c_f32_bf16 v30, v64, v6
    v_dot2c_f32_bf16 v30, v65, v7
    v_dot2c_f32_bf16 v30, v66, v8
    v_dot2c_f32_bf16 v30, v67, v9
    v_mov_b32 v31, 0
    v_dot2c_f32_bf16 v31, v68, v6
    v_dot2c_f32_bf16 v31, v69, v7
    v_dot2c_f32_bf16 v31, v70, v8
    v_dot2c_f32_bf16 v31, v71, v9
    v_mov_b32 v32, 0
    v_dot2c_f32_bf16 v32, v72, v6
    v_dot2c_f32_bf16 v32, v73, v7
    v_dot2c_f32_bf16 v32, v74, v8
    v_dot2c_f32_bf16 v32, v75, v9
    s_addk_i32 s49, 0x4000
    ds_write_b32 v46, v47 offset:288
    v_add_u32 v47, 1, v47
    ds_read_b32 v240, v241 offset:316
    s_waitcnt vmcnt(6)
    s_cbranch_vccnz L_c52
    s_waitcnt vmcnt(4)
L_c52:
    buffer_load_dwordx4 v[64:67], v1, s[8:11], s49 offen nt
    v_mov_b32 v33, 0
    v_dot2c_f32_bf16 v33, v76, v6
    v_dot2c_f32_bf16 v33, v77, v7
    v_dot2c_f32_bf16 v33, v78, v8
    v_dot2c_f32_bf16 v33, v79, v9
    v_mov_b32 v34, 0
    v_dot2c_f32_bf16 v34, v80, v6
    v_dot2c_f32_bf16 v34, v81, v7
    v_dot2c_f32_bf16 v34, v82, v8
    v_dot2c_f32_bf16 v34, v83, v9
    v_mov_b32 v35, 0
    v_dot2c_f32_bf16 v35, v84, v6
    v_dot2c_f32_bf16 v35, v85, v7
    v_dot2c_f32_bf16 v35, v86, v8
    v_dot2c_f32_bf16 v35, v87, v9
    v_mov_b32 v36, 0
    v_dot2c_f32_bf16 v36, v88, v6
    v_dot2c_f32_bf16 v36, v89, v7
    v_dot2c_f32_bf16 v36, v90, v8
    v_dot2c_f32_bf16 v36, v91, v9
    v_mov_b32 v37, 0
    v_dot2c_f32_bf16 v37, v92, v6
    v_dot2c_f32_bf16 v37, v93, v7
    v_dot2c_f32_bf16 v37, v94, v8
    v_dot2c_f32_bf16 v37, v95, v9
    v_mov_b32 v38, 0
    v_dot2c_f32_bf16 v38, v96, v6
    v_dot2c_f32_bf16 v38, v97, v7
    v_dot2c_f32_bf16 v38, v98, v8
    v_dot2c_f32_bf16 v38, v99, v9
    s_waitcnt lgkmcnt(0)
    v_readfirstlane_b32 s58, v240
    s_nop 0
    s_and_b32 vcc_lo, s58, 2
    s_waitcnt vmcnt(6)
    s_cbranch_vccnz L_c53
    s_waitcnt vmcnt(4)
L_c53:
    buffer_load_dwordx4 v[68:71], v1, s[8:11], s49 offen offset:1024 nt
    v_mov_b32 v39, 0
    v_dot2c_f32_bf16 v39, v100, v6
    v_dot2c_f32_bf16 v39, v101, v7
    v_dot2c_f32_bf16 v39, v102, v8
    v_dot2c_f32_bf16 v39, v103, v9
    v_mov_b32 v40, 0
    v_dot2c_f32_bf16 v40, v104, v6
    v_dot2c_f32_bf16 v40, v105, v7
    v_dot2c_f32_bf16 v40, v106, v8
    v_dot2c_f32_bf16 v40, v107, v9
    v_mov_b32 v41, 0
    v_dot2c_f32_bf16 v41, v108, v6
    v_dot2c_f32_bf16 v41, v109, v7
    v_dot2c_f32_bf16 v41, v110, v8
    v_dot2c_f32_bf16 v41, v111, v9
    v_add_f32_dpp v26, v26, v26 row_ror:8 row_mask:0xf bank_mask:0x3
    v_add_f32_dpp v26, v34, v34 row_ror:8 row_mask:0xf bank_mask:0xc
    v_add_f32_dpp v27, v27, v27 row_ror:8 row_mask:0xf bank_mask:0x3
    v_add_f32_dpp v27, v35, v35 row_ror:8 row_mask:0xf bank_mask:0xc
    v_add_f32_dpp v28, v28, v28 row_ror:8 row_mask:0xf bank_mask:0x3
    v_add_f32_dpp v28, v36, v36 row_ror:8 row_mask:0xf bank_mask:0xc
    v_add_f32_dpp v29, v29, v29 row_ror:8 row_mask:0xf bank_mask:0x3
    v_add_f32_dpp v29, v37, v37 row_ror:8 row_mask:0xf bank_mask:0xc
    v_add_f32_dpp v30, v30, v30 row_ror:8 row_mask:0xf bank_mask:0x3
    v_add_f32_dpp v30, v38, v38 row_ror:8 row_mask:0xf bank_mask:0xc
    v_add_f32_dpp v31, v31, v31 row_ror:8 row_mask:0xf bank_mask:0x3
    v_add_f32_dpp v31, v39, v39 row_ror:8 row_mask:0xf bank_mask:0xc
    v_add_f32_dpp v32, v32, v32 row_ror:8 row_mask:0xf bank_mask:0x3
    v_add_f32_dpp v32, v40, v40 row_ror:8 row_mask:0xf bank_mask:0xc
    v_add_f32_dpp v33, v33, v33 row_ror:8 row_mask:0xf bank_mask:0x3
    v_add_f32_dpp v33, v41, v41 row_ror:8 row_mask:0xf bank_mask:0xc
    v_add_f32_dpp v26, v26, v26 row_half_mirror row_mask:0xf bank_mask:0x5
    v_add_f32_dpp v26, v30, v30 row_half_mirror row_mask:0xf bank_mask:0xa
    v_add_f32_dpp v27, v27, v27 row_half_mirror row_mask:0xf bank_mask:0x5
    v_add_f32_dpp v27, v31, v31 row_half_mirror row_mask:0xf bank_mask:0xa
    v_add_f32_dpp v28, v28, v28 row_half_mirror row_mask:0xf bank_mask:0x5
    v_add_f32_dpp v28, v32, v32 row_half_mirror row_mask:0xf bank_mask:0xa
    v_add_f32_dpp v29, v29, v29 row_half_mirror row_mask:0xf bank_mask:0x5
    v_add_f32_dpp v29, v33, v33 row_half_mirror row_mask:0xf bank_mask:0xa
    v_add_f32_dpp v26, v26, v26 quad_perm:[2,3,0,1] row_mask:0xf bank_mask:0xf
    v_add_f32_dpp v27, v27, v27 quad_perm:[2,3,0,1] row_mask:0xf bank_mask:0xf
    v_add_f32_dpp v28, v28, v28 quad_perm:[2,3,0,1] row_mask:0xf bank_mask:0xf
    v_add_f32_dpp v29, v29, v29 quad_perm:[2,3,0,1] row_mask:0xf bank_mask:0xf
    v_cndmask_b32 v26, v26, v28, s[52:53]
    v_cndmask_b32 v27, v27, v29, s[52:53]
    s_nop 0
    v_add_f32_dpp v26, v26, v26 quad_perm:[1,0,3,2] row_mask:0xf bank_mask:0xf
    v_add_f32_dpp v27, v27, v27 quad_perm:[1,0,3,2] row_mask:0xf bank_mask:0xf
    v_cndmask_b32 v10, v26, v27, s[54:55]
    v_cvt_pk_bf16_f32 v10, v10, v10
    v_and_b32 v10, 0xffff0000, v10
    v_mul_f32 v10, 0x3db504f3, v10
    v_cvt_pk_bf16_f32 v10, v10, v10
    v_and_b32 v10, 0xffff0000, v10
    v_mov_b32 v26, 0
    v_dot2c_f32_bf16 v26, v112, v6
    v_dot2c_f32_bf16 v26, v113, v7
    v_dot2c_f32_bf16 v26, v114, v8
    v_dot2c_f32_bf16 v26, v115, v9
    v_mov_b32 v27, 0
    v_dot2c_f32_bf16 v27, v116, v6
    v_dot2c_f32_bf16 v27, v117, v7
    v_dot2c_f32_bf16 v27, v118, v8
    v_dot2c_f32_bf16 v27, v119, v9
    v_mov_b32 v28, 0
    v_dot2c_f32_bf16 v28, v120, v6
    v_dot2c_f32_bf16 v28, v121, v7
    v_dot2c_f32_bf16 v28, v122, v8
    v_dot2c_f32_bf16 v28, v123, v9
    s_waitcnt vmcnt(6)
    s_cbranch_vccnz L_c54
    s_waitcnt vmcnt(4)
L_c54:
    buffer_load_dwordx4 v[72:75], v1, s[8:11], s49 offen offset:2048 nt
    v_mov_b32 v29, 0
    v_dot2c_f32_bf16 v29, v124, v6
    v_dot2c_f32_bf16 v29, v125, v7
    v_dot2c_f32_bf16 v29, v126, v8
    v_dot2c_f32_bf16 v29, v127, v9
    v_mov_b32 v30, 0
    v_dot2c_f32_bf16 v30, v128, v6
    v_dot2c_f32_bf16 v30, v129, v7
    v_dot2c_f32_bf16 v30, v130, v8
    v_dot2c_f32_bf16 v30, v131, v9
    v_mov_b32 v31, 0
    v_dot2c_f32_bf16 v31, v132, v6
    v_dot2c_f32_bf16 v31, v133, v7
    v_dot2c_f32_bf16 v31, v134, v8
    v_dot2c_f32_bf16 v31, v135, v9
    v_mov_b32 v32, 0
    v_dot2c_f32_bf16 v32, v136, v6
    v_dot2c_f32_bf16 v32, v137, v7
    v_dot2c_f32_bf16 v32, v138, v8
    v_dot2c_f32_bf16 v32, v139, v9
    v_mov_b32 v33, 0
    v_dot2c_f32_bf16 v33, v140, v6
    v_dot2c_f32_bf16 v33, v141, v7
    v_dot2c_f32_bf16 v33, v142, v8
    v_dot2c_f32_bf16 v33, v143, v9
    v_mov_b32 v34, 0
    v_dot2c_f32_bf16 v34, v144, v6
    v_dot2c_f32_bf16 v34, v145, v7
    v_dot2c_f32_bf16 v34, v146, v8
    v_dot2c_f32_bf16 v34, v147, v9
    s_waitcnt vmcnt(6)
    s_cbranch_vccnz L_c55
    s_waitcnt vmcnt(4)
L_c55:
    buffer_load_dwordx4 v[76:79], v1, s[8:11], s49 offen offset:3072 nt
    v_mov_b32 v35, 0
    v_dot2c_f32_bf16 v35, v148, v6
    v_dot2c_f32_bf16 v35, v149, v7
    v_dot2c_f32_bf16 v35, v150, v8
    v_dot2c_f32_bf16 v35, v151, v9
    v_mov_b32 v36, 0
    v_dot2c_f32_bf16 v36, v152, v6
    v_dot2c_f32_bf16 v36, v153, v7
    v_dot2c_f32_bf16 v36, v154, v8
    v_dot2c_f32_bf16 v36, v155, v9
    v_mov_b32 v37, 0
    v_dot2c_f32_bf16 v37, v156, v6
    v_dot2c_f32_bf16 v37, v157, v7
    v_dot2c_f32_bf16 v37, v158, v8
    v_dot2c_f32_bf16 v37, v159, v9
    v_mov_b32 v38, 0
    v_dot2c_f32_bf16 v38, v160, v6
    v_dot2c_f32_bf16 v38, v161, v7
    v_dot2c_f32_bf16 v38, v162, v8
    v_dot2c_f32_bf16 v38, v163, v9
    v_mov_b32 v39, 0
    v_dot2c_f32_bf16 v39, v164, v6
    v_dot2c_f32_bf16 v39, v165, v7
    v_dot2c_f32_bf16 v39, v166, v8
    v_dot2c_f32_bf16 v39, v167, v9
    v_mov_b32 v40, 0
    v_dot2c_f32_bf16 v40, v168, v6
    v_dot2c_f32_bf16 v40, v169, v7
    v_dot2c_f32_bf16 v40, v170, v8
    v_dot2c_f32_bf16 v40, v171, v9
    s_addk_i32 s49, 0x4000
    ds_write_b32 v46, v47 offset:288
    v_add_u32 v47, 1, v47
    ds_read_b32 v240, v241 offset:316
    s_waitcnt vmcnt(6)
    s_cbranch_vccnz L_c56
    s_waitcnt vmcnt(4)
L_c56:
    buffer_load_dwordx4 v[80:83], v1, s[8:11], s49 offen nt
    v_mov_b32 v41, 0
    v_dot2c_f32_bf16 v41, v172, v6
    v_dot2c_f32_bf16 v41, v173, v7
    v_dot2c_f32_bf16 v41, v174, v8
    v_dot2c_f32_bf16 v41, v175, v9
    v_add_f32_dpp v26, v26, v26 row_ror:8 row_mask:0xf bank_mask:0x3
    v_add_f32_dpp v26, v34, v34 row_ror:8 row_mask:0xf bank_mask:0xc
    v_add_f32_dpp v27, v27, v27 row_ror:8 row_mask:0xf bank_mask:0x3
    v_add_f32_dpp v27, v35, v35 row_ror:8 row_mask:0xf bank_mask:0xc
    v_add_f32_dpp v28, v28, v28 row_ror:8 row_mask:0xf bank_mask:0x3
    v_add_f32_dpp v28, v36, v36 row_ror:8 row_mask:0xf bank_mask:0xc
    v_add_f32_dpp v29, v29, v29 row_ror:8 row_mask:0xf bank_mask:0x3
    v_add_f32_dpp v29, v37, v37 row_ror:8 row_mask:0xf bank_mask:0xc
    v_add_f32_dpp v30, v30, v30 row_ror:8 row_mask:0xf bank_mask:0x3
    v_add_f32_dpp v30, v38, v38 row_ror:8 row_mask:0xf bank_mask:0xc
    v_add_f32_dpp v31, v31, v31 row_ror:8 row_mask:0xf bank_mask:0x3
    v_add_f32_dpp v31, v39, v39 row_ror:8 row_mask:0xf bank_mask:0xc
    v_add_f32_dpp v32, v32, v32 row_ror:8 row_mask:0xf bank_mask:0x3
    v_add_f32_dpp v32, v40, v40 row_ror:8 row_mask:0xf bank_mask:0xc
    v_add_f32_dpp v33, v33, v33 row_ror:8 row_mask:0xf bank_mask:0x3
    v_add_f32_dpp v33, v41, v41 row_ror:8 row_mask:0xf bank_mask:0xc
    v_add_f32_dpp v26, v26, v26 row_half_mirror row_mask:0xf bank_mask:0x5
    v_add_f32_dpp v26, v30, v30 row_half_mirror row_mask:0xf bank_mask:0xa
    v_add_f32_dpp v27, v27, v27 row_half_mirror row_mask:0xf bank_mask:0x5
    v_add_f32_dpp v27, v31, v31 row_half_mirror row_mask:0xf bank_mask:0xa
    v_add_f32_dpp v28, v28, v28 row_half_mirror row_mask:0xf bank_mask:0x5
    v_add_f32_dpp v28, v32, v32 row_half_mirror row_mask:0xf bank_mask:0xa
    v_add_f32_dpp v29, v29, v29 row_half_mirror row_mask:0xf bank_mask:0x5
    v_add_f32_dpp v29, v33, v33 row_half_mirror row_mask:0xf bank_mask:0xa
    v_add_f32_dpp v26, v26, v26 quad_perm:[2,3,0,1] row_mask:0xf bank_mask:0xf
    v_add_f32_dpp v27, v27, v27 quad_perm:[2,3,0,1] row_mask:0xf bank_mask:0xf
    v_add_f32_dpp v28, v28, v28 quad_perm:[2,3,0,1] row_mask:0xf bank_mask:0xf
    v_add_f32_dpp v29, v29, v29 quad_perm:[2,3,0,1] row_mask:0xf bank_mask:0xf
    v_cndmask_b32 v26, v26, v28, s[52:53]
    v_cndmask_b32 v27, v27, v29, s[52:53]
    s_nop 0
    v_add_f32_dpp v26, v26, v26 quad_perm:[1,0,3,2] row_mask:0xf bank_mask:0xf
    v_add_f32_dpp v27, v27, v27 quad_perm:[1,0,3,2] row_mask:0xf bank_mask:0xf
    v_cndmask_b32 v11, v26, v27, s[54:55]
    v_cvt_pk_bf16_f32 v11, v11, v11
    v_and_b32 v11, 0xffff0000, v11
    v_mul_f32 v11, 0x3db504f3, v11
    v_cvt_pk_bf16_f32 v11, v11, v11
    v_and_b32 v11, 0xffff0000, v11
    v_mov_b32 v26, 0
    v_dot2c_f32_bf16 v26, v176, v6
    v_dot2c_f32_bf16 v26, v177, v7
    v_dot2c_f32_bf16 v26, v178, v8
    v_dot2c_f32_bf16 v26, v179, v9
    v_mov_b32 v27, 0
    v_dot2c_f32_bf16 v27, v180, v6
    v_dot2c_f32_bf16 v27, v181, v7
    v_dot2c_f32_bf16 v27, v182, v8
    v_dot2c_f32_bf16 v27, v183, v9
    v_mov_b32 v28, 0
    v_dot2c_f32_bf16 v28, v184, v6
    v_dot2c_f32_bf16 v28, v185, v7
    v_dot2c_f32_bf16 v28, v186, v8
    v_dot2c_f32_bf16 v28, v187, v9
    v_mov_b32 v29, 0
    v_dot2c_f32_bf16 v29, v188, v6
    v_dot2c_f32_bf16 v29, v189, v7
    v_dot2c_f32_bf16 v29, v190, v8
    v_dot2c_f32_bf16 v29, v191, v9
    v_mov_b32 v30, 0
    v_dot2c_f32_bf16 v30, v192, v6
    v_dot2c_f32_bf16 v30, v193, v7
    v_dot2c_f32_bf16 v30, v194, v8
    v_dot2c_f32_bf16 v30, v195, v9
    s_waitcnt lgkmcnt(0)
    v_readfirstlane_b32 s58, v240
    s_nop 0
    s_and_b32 vcc_lo, s58, 2
    s_waitcnt vmcnt(6)
    s_cbranch_vccnz L_c57
    s_waitcnt vmcnt(4)
L_c57:
    buffer_load_dwordx4 v[84:87], v1, s[8:11], s49 offen offset:1024 nt
    v_mov_b32 v31, 0
    v_dot2c_f32_bf16 v31, v196, v6
    v_dot2c_f32_bf16 v31, v197, v7
    v_dot2c_f32_bf16 v31, v198, v8
    v_dot2c_f32_bf16 v31, v199, v9
    v_mov_b32 v32, 0
    v_dot2c_f32_bf16 v32, v200, v6
    v_dot2c_f32_bf16 v32, v201, v7
    v_dot2c_f32_bf16 v32, v202, v8
    v_dot2c_f32_bf16 v32, v203, v9
    v_mov_b32 v33, 0
    v_dot2c_f32_bf16 v33, v204, v6
    v_dot2c_f32_bf16 v33, v205, v7
    v_dot2c_f32_bf16 v33, v206, v8
    v_dot2c_f32_bf16 v33, v207, v9
    v_mov_b32 v34, 0
    v_dot2c_f32_bf16 v34, v208, v6
    v_dot2c_f32_bf16 v34, v209, v7
    v_dot2c_f32_bf16 v34, v210, v8
    v_dot2c_f32_bf16 v34, v211, v9
    v_mov_b32 v35, 0
    v_dot2c_f32_bf16 v35, v212, v6
    v_dot2c_f32_bf16 v35, v213, v7
    v_dot2c_f32_bf16 v35, v214, v8
    v_dot2c_f32_bf16 v35, v215, v9
    v_mov_b32 v36, 0
    v_dot2c_f32_bf16 v36, v216, v6
    v_dot2c_f32_bf16 v36, v217, v7
    v_dot2c_f32_bf16 v36, v218, v8
    v_dot2c_f32_bf16 v36, v219, v9
    s_waitcnt vmcnt(6)
    s_cbranch_vccnz L_c58
    s_waitcnt vmcnt(4)
L_c58:
    buffer_load_dwordx4 v[88:91], v1, s[8:11], s49 offen offset:2048 nt
    v_mov_b32 v37, 0
    v_dot2c_f32_bf16 v37, v220, v6
    v_dot2c_f32_bf16 v37, v221, v7
    v_dot2c_f32_bf16 v37, v222, v8
    v_dot2c_f32_bf16 v37, v223, v9
    v_mov_b32 v38, 0
    v_dot2c_f32_bf16 v38, v224, v6
    v_dot2c_f32_bf16 v38, v225, v7
    v_dot2c_f32_bf16 v38, v226, v8
    v_dot2c_f32_bf16 v38, v227, v9
    v_mov_b32 v39, 0
    v_dot2c_f32_bf16 v39, v228, v6
    v_dot2c_f32_bf16 v39, v229, v7
    v_dot2c_f32_bf16 v39, v230, v8
    v_dot2c_f32_bf16 v39, v231, v9
    v_mov_b32 v40, 0
    v_dot2c_f32_bf16 v40, v232, v6
    v_dot2c_f32_bf16 v40, v233, v7
    v_dot2c_f32_bf16 v40, v234, v8
    v_dot2c_f32_bf16 v40, v235, v9
    v_mov_b32 v41, 0
    v_dot2c_f32_bf16 v41, v236, v6
    v_dot2c_f32_bf16 v41, v237, v7
    v_dot2c_f32_bf16 v41, v238, v8
    v_dot2c_f32_bf16 v41, v239, v9
    v_add_f32_dpp v26, v26, v26 row_ror:8 row_mask:0xf bank_mask:0x3
    v_add_f32_dpp v26, v34, v34 row_ror:8 row_mask:0xf bank_mask:0xc
    v_add_f32_dpp v27, v27, v27 row_ror:8 row_mask:0xf bank_mask:0x3
    v_add_f32_dpp v27, v35, v35 row_ror:8 row_mask:0xf bank_mask:0xc
    v_add_f32_dpp v28, v28, v28 row_ror:8 row_mask:0xf bank_mask:0x3
    v_add_f32_dpp v28, v36, v36 row_ror:8 row_mask:0xf bank_mask:0xc
    v_add_f32_dpp v29, v29, v29 row_ror:8 row_mask:0xf bank_mask:0x3
    v_add_f32_dpp v29, v37, v37 row_ror:8 row_mask:0xf bank_mask:0xc
    v_add_f32_dpp v30, v30, v30 row_ror:8 row_mask:0xf bank_mask:0x3
    v_add_f32_dpp v30, v38, v38 row_ror:8 row_mask:0xf bank_mask:0xc
    v_add_f32_dpp v31, v31, v31 row_ror:8 row_mask:0xf bank_mask:0x3
    v_add_f32_dpp v31, v39, v39 row_ror:8 row_mask:0xf bank_mask:0xc
    v_add_f32_dpp v32, v32, v32 row_ror:8 row_mask:0xf bank_mask:0x3
    v_add_f32_dpp v32, v40, v40 row_ror:8 row_mask:0xf bank_mask:0xc
    v_add_f32_dpp v33, v33, v33 row_ror:8 row_mask:0xf bank_mask:0x3
    v_add_f32_dpp v33, v41, v41 row_ror:8 row_mask:0xf bank_mask:0xc
    s_waitcnt vmcnt(6)
    s_cbranch_vccnz L_c59
    s_waitcnt vmcnt(4)
L_c59:
    buffer_load_dwordx4 v[92:95], v1, s[8:11], s49 offen offset:3072 nt
    v_add_f32_dpp v26, v26, v26 row_half_mirror row_mask:0xf bank_mask:0x5
    v_add_f32_dpp v26, v30, v30 row_half_mirror row_mask:0xf bank_mask:0xa
    v_add_f32_dpp v27, v27, v27 row_half_mirror row_mask:0xf bank_mask:0x5
    v_add_f32_dpp v27, v31, v31 row_half_mirror row_mask:0xf bank_mask:0xa
    v_add_f32_dpp v28, v28, v28 row_half_mirror row_mask:0xf bank_mask:0x5
    v_add_f32_dpp v28, v32, v32 row_half_mirror row_mask:0xf bank_mask:0xa
    v_add_f32_dpp v29, v29, v29 row_half_mirror row_mask:0xf bank_mask:0x5
    v_add_f32_dpp v29, v33, v33 row_half_mirror row_mask:0xf bank_mask:0xa
    v_add_f32_dpp v26, v26, v26 quad_perm:[2,3,0,1] row_mask:0xf bank_mask:0xf
    v_add_f32_dpp v27, v27, v27 quad_perm:[2,3,0,1] row_mask:0xf bank_mask:0xf
    v_add_f32_dpp v28, v28, v28 quad_perm:[2,3,0,1] row_mask:0xf bank_mask:0xf
    v_add_f32_dpp v29, v29, v29 quad_perm:[2,3,0,1] row_mask:0xf bank_mask:0xf
    v_cndmask_b32 v26, v26, v28, s[52:53]
    v_cndmask_b32 v27, v27, v29, s[52:53]
    s_nop 0
    v_add_f32_dpp v26, v26, v26 quad_perm:[1,0,3,2] row_mask:0xf bank_mask:0xf
    v_add_f32_dpp v27, v27, v27 quad_perm:[1,0,3,2] row_mask:0xf bank_mask:0xf
    v_cndmask_b32 v12, v26, v27, s[54:55]
    v_cvt_pk_bf16_f32 v12, v12, v12
    v_and_b32 v12, 0xffff0000, v12
    v_mul_f32 v12, 0x3db504f3, v12
    v_cvt_pk_bf16_f32 v12, v12, v12
    v_and_b32 v12, 0xffff0000, v12
    v_mov_b32 v26, 0
    v_dot2c_f32_bf16 v26, v48, v6
    v_dot2c_f32_bf16 v26, v49, v7
    v_dot2c_f32_bf16 v26, v50, v8
    v_dot2c_f32_bf16 v26, v51, v9
    v_mov_b32 v27, 0
    v_dot2c_f32_bf16 v27, v52, v6
    v_dot2c_f32_bf16 v27, v53, v7
    v_dot2c_f32_bf16 v27, v54, v8
    v_dot2c_f32_bf16 v27, v55, v9
    v_mov_b32 v28, 0
    v_dot2c_f32_bf16 v28, v56, v6
    v_dot2c_f32_bf16 v28, v57, v7
    v_dot2c_f32_bf16 v28, v58, v8
    v_dot2c_f32_bf16 v28, v59, v9
    v_mov_b32 v29, 0
    v_dot2c_f32_bf16 v29, v60, v6
    v_dot2c_f32_bf16 v29, v61, v7
    v_dot2c_f32_bf16 v29, v62, v8
    v_dot2c_f32_bf16 v29, v63, v9
    v_mov_b32 v30, 0
    v_dot2c_f32_bf16 v30, v64, v6
    v_dot2c_f32_bf16 v30, v65, v7
    v_dot2c_f32_bf16 v30, v66, v8
    v_dot2c_f32_bf16 v30, v67, v9
    v_mov_b32 v31, 0
    s_waitcnt vmcnt(6)
    s_addk_i32 s49, 0x4000
    ds_write_b32 v46, v47 offset:288
    v_add_u32 v47, 1, v47
    ds_read_b32 v240, v241 offset:316
    s_cbranch_vccnz L_c60
    s_waitcnt vmcnt(4)
L_c60:
    buffer_load_dwordx4 v[96:99], v1, s[8:11], s49 offen nt
    v_dot2c_f32_bf16 v31, v68, v6
    v_dot2c_f32_bf16 v31, v69, v7
    v_dot2c_f32_bf16 v31, v70, v8
    v_dot2c_f32_bf16 v31, v71, v9
    v_mov_b32 v32, 0
    s_waitcnt vmcnt(6)
    s_waitcnt lgkmcnt(0)
    v_readfirstlane_b32 s58, v240
    s_nop 0
    s_and_b32 vcc_lo, s58, 2
    s_cbranch_vccnz L_c61
    s_waitcnt vmcnt(4)
L_c61:
    buffer_load_dwordx4 v[100:103], v1, s[8:11], s49 offen offset:1024 nt
    v_dot2c_f32_bf16 v32, v72, v6
    v_dot2c_f32_bf16 v32, v73, v7
    v_dot2c_f32_bf16 v32, v74, v8
    v_dot2c_f32_bf16 v32, v75, v9
    v_mov_b32 v33, 0
    s_waitcnt vmcnt(6)
    s_cbranch_vccnz L_c62
    s_waitcnt vmcnt(4)
L_c62:
    buffer_load_dwordx4 v[104:107], v1, s[8:11], s49 offen offset:2048 nt
    v_dot2c_f32_bf16 v33, v76, v6
    v_dot2c_f32_bf16 v33, v77, v7
    v_dot2c_f32_bf16 v33, v78, v8
    v_dot2c_f32_bf16 v33, v79, v9
    v_mov_b32 v34, 0
    s_waitcnt vmcnt(6)
    s_cbranch_vccnz L_c63
    s_waitcnt vmcnt(4)
L_c63:
    buffer_load_dwordx4 v[108:111], v1, s[8:11], s49 offen offset:3072 nt
    v_dot2c_f32_bf16 v34, v80, v6
    v_dot2c_f32_bf16 v34, v81, v7
    v_dot2c_f32_bf16 v34, v82, v8
    v_dot2c_f32_bf16 v34, v83, v9
    v_mov_b32 v35, 0
    s_waitcnt vmcnt(6)
    s_mov_b32 s49, s48
    ds_write_b32 v46, v47 offset:288
    v_add_u32 v47, 1, v47
    ds_read_b32 v240, v241 offset:316
    s_cbranch_vccnz L_c64
    s_waitcnt vmcnt(4)
L_c64:
    buffer_load_dwordx4 v[112:115], v1, s[12:15], s49 offen nt
    v_dot2c_f32_bf16 v35, v84, v6
    v_dot2c_f32_bf16 v35, v85, v7
    v_dot2c_f32_bf16 v35, v86, v8
    v_dot2c_f32_bf16 v35, v87, v9
    v_mov_b32 v36, 0
    s_waitcnt vmcnt(6)
    s_waitcnt lgkmcnt(0)
    v_readfirstlane_b32 s58, v240
    s_nop 0
    s_and_b32 vcc_lo, s58, 2
    s_cbranch_vccnz L_c65
    s_waitcnt vmcnt(4)
L_c65:
    buffer_load_dwordx4 v[116:119], v1, s[12:15], s49 offen offset:1024 nt
    v_dot2c_f32_bf16 v36, v88, v6
    v_dot2c_f32_bf16 v36, v89, v7
    v_dot2c_f32_bf16 v36, v90, v8
    v_dot2c_f32_bf16 v36, v91, v9
    v_mov_b32 v37, 0
    s_waitcnt vmcnt(6)
    s_cbranch_vccnz L_c66
    s_waitcnt vmcnt(4)
L_c66:
    buffer_load_dwordx4 v[120:123], v1, s[12:15], s49 offen offset:2048 nt
    v_dot2c_f32_bf16 v37, v92, v6
    v_dot2c_f32_bf16 v37, v93, v7
    v_dot2c_f32_bf16 v37, v94, v8
    v_dot2c_f32_bf16 v37, v95, v9
    v_mov_b32 v38, 0
    s_waitcnt vmcnt(6)
    s_cbranch_vccnz L_c67
    s_waitcnt vmcnt(4)
L_c67:
    buffer_load_dwordx4 v[124:127], v1, s[12:15], s49 offen offset:3072 nt
    v_dot2c_f32_bf16 v38, v96, v6
    v_dot2c_f32_bf16 v38, v97, v7
    v_dot2c_f32_bf16 v38, v98, v8
    v_dot2c_f32_bf16 v38, v99, v9
    v_mov_b32 v39, 0
    s_waitcnt vmcnt(6)
    s_addk_i32 s49, 0x4000
    ds_write_b32 v46, v47 offset:288
    v_add_u32 v47, 1, v47
    ds_read_b32 v240, v241 offset:316
    s_cbranch_vccnz L_c68
    s_waitcnt vmcnt(4)
L_c68:
    buffer_load_dwordx4 v[128:131], v1, s[12:15], s49 offen nt
    v_dot2c_f32_bf16 v39, v100, v6
    v_dot2c_f32_bf16 v39, v101, v7
    v_dot2c_f32_bf16 v39, v102, v8
    v_dot2c_f32_bf16 v39, v103, v9
    v_mov_b32 v40, 0
    s_waitcnt vmcnt(6)
    s_waitcnt lgkmcnt(0)
    v_readfirstlane_b32 s58, v240
    s_nop 0
    s_and_b32 vcc_lo, s58, 2
    s_cbranch_vccnz L_c69
    s_waitcnt vmcnt(4)
L_c69:
    buffer_load_dwordx4 v[132:135], v1, s[12:15], s49 offen offset:1024 nt
    v_dot2c_f32_bf16 v40, v104, v6
    v_dot2c_f32_bf16 v40, v105, v7
    v_dot2c_f32_bf16 v40, v106, v8
    v_dot2c_f32_bf16 v40, v107, v9
    v_mov_b32 v41, 0
    s_waitcnt vmcnt(6)
    s_cbranch_vccnz L_c70
    s_waitcnt vmcnt(4)
L_c70:
    buffer_load_dwordx4 v[136:139], v1, s[12:15], s49 offen offset:2048 nt
    v_dot2c_f32_bf16 v41, v108, v6
    v_dot2c_f32_bf16 v41, v109, v7
    v_dot2c_f32_bf16 v41, v110, v8
    v_dot2c_f32_bf16 v41, v111, v9
    v_add_f32_dpp v26, v26, v26 row_ror:8 row_mask:0xf bank_mask:0x3
    v_add_f32_dpp v26, v34, v34 row_ror:8 row_mask:0xf bank_mask:0xc
    v_add_f32_dpp v27, v27, v27 row_ror:8 row_mask:0xf bank_mask:0x3
    v_add_f32_dpp v27, v35, v35 row_ror:8 row_mask:0xf bank_mask:0xc
    v_add_f32_dpp v28, v28, v28 row_ror:8 row_mask:0xf bank_mask:0x3
    v_add_f32_dpp v28, v36, v36 row_ror:8 row_mask:0xf bank_mask:0xc
    v_add_f32_dpp v29, v29, v29 row_ror:8 row_mask:0xf bank_mask:0x3
    v_add_f32_dpp v29, v37, v37 row_ror:8 row_mask:0xf bank_mask:0xc
    v_add_f32_dpp v30, v30, v30 row_ror:8 row_mask:0xf bank_mask:0x3
    v_add_f32_dpp v30, v38, v38 row_ror:8 row_mask:0xf bank_mask:0xc
    v_add_f32_dpp v31, v31, v31 row_ror:8 row_mask:0xf bank_mask:0x3
    v_add_f32_dpp v31, v39, v39 row_ror:8 row_mask:0xf bank_mask:0xc
    v_add_f32_dpp v32, v32, v32 row_ror:8 row_mask:0xf bank_mask:0x3
    v_add_f32_dpp v32, v40, v40 row_ror:8 row_mask:0xf bank_mask:0xc
    v_add_f32_dpp v33, v33, v33 row_ror:8 row_mask:0xf bank_mask:0x3
    v_add_f32_dpp v33, v41, v41 row_ror:8 row_mask:0xf bank_mask:0xc
    s_waitcnt vmcnt(6)
    s_cbranch_vccnz L_c71
    s_waitcnt vmcnt(4)
L_c71:
    buffer_load_dwordx4 v[140:143], v1, s[12:15], s49 offen offset:3072 nt
    v_add_f32_dpp v26, v26, v26 row_half_mirror row_mask:0xf bank_mask:0x5
    v_add_f32_dpp v26, v30, v30 row_half_mirror row_mask:0xf bank_mask:0xa
    v_add_f32_dpp v27, v27, v27 row_half_mirror row_mask:0xf bank_mask:0x5
    v_add_f32_dpp v27, v31, v31 row_half_mirror row_mask:0xf bank_mask:0xa
    v_add_f32_dpp v28, v28, v28 row_half_mirror row_mask:0xf bank_mask:0x5
    v_add_f32_dpp v28, v32, v32 row_half_mirror row_mask:0xf bank_mask:0xa
    v_add_f32_dpp v29, v29, v29 row_half_mirror row_mask:0xf bank_mask:0x5
    v_add_f32_dpp v29, v33, v33 row_half_mirror row_mask:0xf bank_mask:0xa
    v_add_f32_dpp v26, v26, v26 quad_perm:[2,3,0,1] row_mask:0xf bank_mask:0xf
    v_add_f32_dpp v27, v27, v27 quad_perm:[2,3,0,1] row_mask:0xf bank_mask:0xf
    v_add_f32_dpp v28, v28, v28 quad_perm:[2,3,0,1] row_mask:0xf bank_mask:0xf
    v_add_f32_dpp v29, v29, v29 quad_perm:[2,3,0,1] row_mask:0xf bank_mask:0xf
    v_cndmask_b32 v26, v26, v28, s[52:53]
    v_cndmask_b32 v27, v27, v29, s[52:53]
    s_nop 0
    v_add_f32_dpp v26, v26, v26 quad_perm:[1,0,3,2] row_mask:0xf bank_mask:0xf
    v_add_f32_dpp v27, v27, v27 quad_perm:[1,0,3,2] row_mask:0xf bank_mask:0xf
    v_cndmask_b32 v13, v26, v27, s[54:55]
    v_cvt_pk_bf16_f32 v13, v13, v13
    v_and_b32 v13, 0xffff0000, v13
    v_mul_f32 v13, 0x3db504f3, v13
    v_cvt_pk_bf16_f32 v13, v13, v13
    v_and_b32 v13, 0xffff0000, v13
    v_max3_f32 v42, v10, v11, v12
    v_max_f32 v42, v42, v13
    s_nop 1
    v_max_f32_dpp v42, v42, v42 quad_perm:[1,0,3,2] row_mask:0xf bank_mask:0xf
    s_nop 1
    v_max_f32_dpp v42, v42, v42 quad_perm:[2,3,0,1] row_mask:0xf bank_mask:0xf
    s_nop 1
    v_max_f32_dpp v42, v42, v42 row_half_mirror row_mask:0xf bank_mask:0xf
    s_nop 1
    v_max_f32_dpp v42, v42, v42 row_mirror row_mask:0xf bank_mask:0xf
    s_nop 1
    v_max_f32_dpp v42, v42, v42 row_bcast:15 row_mask:0xa bank_mask:0xf
    s_nop 1
    v_max_f32_dpp v42, v42, v42 row_bcast:31 row_mask:0xc bank_mask:0xf
    s_addk_i32 s49, 0x4000
    ds_write_b32 v46, v47 offset:288
    v_add_u32 v47, 1, v47
    ds_read_b32 v240, v241 offset:316
    s_waitcnt vmcnt(6)
    s_cbranch_vccnz L_c72
    s_waitcnt vmcnt(4)
L_c72:
    buffer_load_dwordx4 v[144:147], v1, s[12:15], s49 offen nt
    v_readlane_b32 s51, v42, 63
    s_nop 1
    v_subrev_f32 v10, s51, v10
    v_subrev_f32 v11, s51, v11
    v_subrev_f32 v12, s51, v12
    v_subrev_f32 v13, s51, v13
    v_mul_f32 v10, 0x3fb8aa3b, v10
    v_mul_f32 v11, 0x3fb8aa3b, v11
    v_mul_f32 v12, 0x3fb8aa3b, v12
    v_mul_f32 v13, 0x3fb8aa3b, v13
    v_exp_f32 v10, v10
    v_exp_f32 v11, v11
    v_exp_f32 v12, v12
    v_exp_f32 v13, v13
    v_add_f32 v43, v10, v11
    v_add_f32 v45, v12, v13
    v_add_f32 v43, v43, v45
    v_cvt_pk_bf16_f32 v10, v10, v10
    v_cvt_pk_bf16_f32 v11, v11, v11
    v_cvt_pk_bf16_f32 v12, v12, v12
    v_cvt_pk_bf16_f32 v13, v13, v13
    v_and_b32_dpp v14, v10, v2 row_newbcast:0 row_mask:0xf bank_mask:0xf
    v_and_b32_dpp v15, v10, v3 row_newbcast:0 row_mask:0xf bank_mask:0xf
    v_and_b32_dpp v16, v10, v4 row_newbcast:0 row_mask:0xf bank_mask:0xf
    v_and_b32_dpp v17, v10, v5 row_newbcast:0 row_mask:0xf bank_mask:0xf
    s_waitcnt lgkmcnt(0)
    v_readfirstlane_b32 s58, v240
    s_nop 0
    s_and_b32 vcc_lo, s58, 2
    s_waitcnt vmcnt(6)
    s_cbranch_vccnz L_c73
    s_waitcnt vmcnt(4)
L_c73:
    buffer_load_dwordx4 v[148:151], v1, s[12:15], s49 offen offset:1024 nt
    v_add_f32_dpp v43, v43, v43 quad_perm:[1,0,3,2] row_mask:0xf bank_mask:0xf
    s_nop 1
    v_add_f32_dpp v43, v43, v43 quad_perm:[2,3,0,1] row_mask:0xf bank_mask:0xf
    s_nop 1
    v_add_f32_dpp v43, v43, v43 row_half_mirror row_mask:0xf bank_mask:0xf
    s_nop 1
    v_add_f32_dpp v43, v43, v43 row_mirror row_mask:0xf bank_mask:0xf
    s_nop 1
    v_add_f32_dpp v43, v43, v43 row_bcast:15 row_mask:0xa bank_mask:0xf
    s_nop 1
    v_add_f32_dpp v43, v43, v43 row_bcast:31 row_mask:0xc bank_mask:0xf
    v_lshlrev_b32 v45, 1, v46
    s_mov_b32 exec_lo, 0
    s_mov_b32 exec_hi, 0x80000000
    ds_write_b64 v45, v[42:43] offset:256
    s_mov_b64 exec, -1
    v_and_b32 v42, 15, v0
    v_lshlrev_b32 v42, 5, v42
    v_and_b32 v44, 16, v0
    v_add_u32 v42, v42, v44
    v_lshl_add_u32 v42, v46, 7, v42
    v_mov_b32 v43, 0
    v_mfma_f32_16x16x32_bf16 v[22:25], v[14:17], v[112:115], 0
    v_and_b32_dpp v18, v10, v2 row_newbcast:1 row_mask:0xf bank_mask:0xf
    v_and_b32_dpp v19, v10, v3 row_newbcast:1 row_mask:0xf bank_mask:0xf
    v_and_b32_dpp v20, v10, v4 row_newbcast:1 row_mask:0xf bank_mask:0xf
    v_and_b32_dpp v21, v10, v5 row_newbcast:1 row_mask:0xf bank_mask:0xf
    s_nop 1
    v_mfma_f32_16x16x32_bf16 v[22:25], v[18:21], v[116:119], v[22:25]
    v_and_b32_dpp v14, v10, v2 row_newbcast:2 row_mask:0xf bank_mask:0xf
    v_and_b32_dpp v15, v10, v3 row_newbcast:2 row_mask:0xf bank_mask:0xf
    v_and_b32_dpp v16, v10, v4 row_newbcast:2 row_mask:0xf bank_mask:0xf
    v_and_b32_dpp v17, v10, v5 row_newbcast:2 row_mask:0xf bank_mask:0xf
    s_nop 1
    v_mfma_f32_16x16x32_bf16 v[22:25], v[14:17], v[120:123], v[22:25]
    v_and_b32_dpp v18, v10, v2 row_newbcast:3 row_mask:0xf bank_mask:0xf
    v_and_b32_dpp v19, v10, v3 row_newbcast:3 row_mask:0xf bank_mask:0xf
    v_and_b32_dpp v20, v10, v4 row_newbcast:3 row_mask:0xf bank_mask:0xf
    v_and_b32_dpp v21, v10, v5 row_newbcast:3 row_mask:0xf bank_mask:0xf
    s_waitcnt vmcnt(6)
    s_cbranch_vccnz L_c74
    s_waitcnt vmcnt(4)
L_c74:
    buffer_load_dwordx4 v[152:155], v1, s[12:15], s49 offen offset:2048 nt
    v_mfma_f32_16x16x32_bf16 v[22:25], v[18:21], v[124:127], v[22:25]
    v_and_b32_dpp v14, v10, v2 row_newbcast:4 row_mask:0xf bank_mask:0xf
    v_and_b32_dpp v15, v10, v3 row_newbcast:4 row_mask:0xf bank_mask:0xf
    v_and_b32_dpp v16, v10, v4 row_newbcast:4 row_mask:0xf bank_mask:0xf
    v_and_b32_dpp v17, v10, v5 row_newbcast:4 row_mask:0xf bank_mask:0xf
    s_waitcnt vmcnt(6)
    s_cbranch_vccnz L_c75
    s_waitcnt vmcnt(4)
L_c75:
    buffer_load_dwordx4 v[156:159], v1, s[12:15], s49 offen offset:3072 nt
    v_mfma_f32_16x16x32_bf16 v[22:25], v[14:17], v[128:131], v[22:25]
    v_and_b32_dpp v18, v10, v2 row_newbcast:5 row_mask:0xf bank_mask:0xf
    v_and_b32_dpp v19, v10, v3 row_newbcast:5 row_mask:0xf bank_mask:0xf
    v_and_b32_dpp v20, v10, v4 row_newbcast:5 row_mask:0xf bank_mask:0xf
    v_and_b32_dpp v21, v10, v5 row_newbcast:5 row_mask:0xf bank_mask:0xf
    s_waitcnt vmcnt(6)
    s_addk_i32 s49, 0x4000
    ds_write_b32 v46, v47 offset:288
    v_add_u32 v47, 1, v47
    ds_read_b32 v240, v241 offset:316
    s_cbranch_vccnz L_c76
    s_waitcnt vmcnt(4)
L_c76:
    buffer_load_dwordx4 v[160:163], v1, s[12:15], s49 offen nt
    v_mfma_f32_16x16x32_bf16 v[22:25], v[18:21], v[132:135], v[22:25]
    v_and_b32_dpp v14, v10, v2 row_newbcast:6 row_mask:0xf bank_mask:0xf
    v_and_b32_dpp v15, v10, v3 row_newbcast:6 row_mask:0xf bank_mask:0xf
    v_and_b32_dpp v16, v10, v4 row_newbcast:6 row_mask:0xf bank_mask:0xf
    v_and_b32_dpp v17, v10, v5 row_newbcast:6 row_mask:0xf bank_mask:0xf
    s_waitcnt vmcnt(6)
    s_waitcnt lgkmcnt(0)
    v_readfirstlane_b32 s58, v240
    s_nop 0
    s_and_b32 vcc_lo, s58, 2
    s_cbranch_vccnz L_c77
    s_waitcnt vmcnt(4)
L_c77:
    buffer_load_dwordx4 v[164:167], v1, s[12:15], s49 offen offset:1024 nt
    v_mfma_f32_16x16x32_bf16 v[22:25], v[14:17], v[136:139], v[22:25]
    v_and_b32_dpp v18, v10, v2 row_newbcast:7 row_mask:0xf bank_mask:0xf
    v_and_b32_dpp v19, v10, v3 row_newbcast:7 row_mask:0xf bank_mask:0xf
    v_and_b32_dpp v20, v10, v4 row_newbcast:7 row_mask:0xf bank_mask:0xf
    v_and_b32_dpp v21, v10, v5 row_newbcast:7 row_mask:0xf bank_mask:0xf
    s_waitcnt vmcnt(6)
    s_cbranch_vccnz L_c78
    s_waitcnt vmcnt(4)
L_c78:
    buffer_load_dwordx4 v[168:171], v1, s[12:15], s49 offen offset:2048 nt
    v_mfma_f32_16x16x32_bf16 v[22:25], v[18:21], v[140:143], v[22:25]
    v_and_b32_dpp v14, v10, v2 row_newbcast:8 row_mask:0xf bank_mask:0xf
    v_and_b32_dpp v15, v10, v3 row_newbcast:8 row_mask:0xf bank_mask:0xf
    v_and_b32_dpp v16, v10, v4 row_newbcast:8 row_mask:0xf bank_mask:0xf
    v_and_b32_dpp v17, v10, v5 row_newbcast:8 row_mask:0xf bank_mask:0xf
    s_waitcnt vmcnt(6)
    s_cbranch_vccnz L_c79
    s_waitcnt vmcnt(4)
L_c79:
    buffer_load_dwordx4 v[172:175], v1, s[12:15], s49 offen offset:3072 nt
    v_mfma_f32_16x16x32_bf16 v[22:25], v[14:17], v[144:147], v[22:25]
    v_and_b32_dpp v18, v10, v2 row_newbcast:9 row_mask:0xf bank_mask:0xf
    v_and_b32_dpp v19, v10, v3 row_newbcast:9 row_mask:0xf bank_mask:0xf
    v_and_b32_dpp v20, v10, v4 row_newbcast:9 row_mask:0xf bank_mask:0xf
    v_and_b32_dpp v21, v10, v5 row_newbcast:9 row_mask:0xf bank_mask:0xf
    s_waitcnt vmcnt(6)
    s_addk_i32 s49, 0x4000
    ds_write_b32 v46, v47 offset:288
    v_add_u32 v47, 1, v47
    ds_read_b32 v240, v241 offset:316
    s_cbranch_vccnz L_c80
    s_waitcnt vmcnt(4)
L_c80:
    buffer_load_dwordx4 v[176:179], v1, s[12:15], s49 offen nt
    v_mfma_f32_16x16x32_bf16 v[22:25], v[18:21], v[148:151], v[22:25]
    v_and_b32_dpp v14, v10, v2 row_newbcast:10 row_mask:0xf bank_mask:0xf
    v_and_b32_dpp v15, v10, v3 row_newbcast:10 row_mask:0xf bank_mask:0xf
    v_and_b32_dpp v16, v10, v4 row_newbcast:10 row_mask:0xf bank_mask:0xf
    v_and_b32_dpp v17, v10, v5 row_newbcast:10 row_mask:0xf bank_mask:0xf
    s_waitcnt vmcnt(6)
    s_waitcnt lgkmcnt(0)
    v_readfirstlane_b32 s58, v240
    s_nop 0
    s_and_b32 vcc_lo, s58, 2
    s_cbranch_vccnz L_c81
    s_waitcnt vmcnt(4)
L_c81:
    buffer_load_dwordx4 v[180:183], v1, s[12:15], s49 offen offset:1024 nt
    v_mfma_f32_16x16x32_bf16 v[22:25], v[14:17], v[152:155], v[22:25]
    v_and_b32_dpp v18, v10, v2 row_newbcast:11 row_mask:0xf bank_mask:0xf
    v_and_b32_dpp v19, v10, v3 row_newbcast:11 row_mask:0xf bank_mask:0xf
    v_and_b32_dpp v20, v10, v4 row_newbcast:11 row_mask:0xf bank_mask:0xf
    v_and_b32_dpp v21, v10, v5 row_newbcast:11 row_mask:0xf bank_mask:0xf
    s_waitcnt vmcnt(6)
    s_cbranch_vccnz L_c82
    s_waitcnt vmcnt(4)
L_c82:
    buffer_load_dwordx4 v[184:187], v1, s[12:15], s49 offen offset:2048 nt
    v_mfma_f32_16x16x32_bf16 v[22:25], v[18:21], v[156:159], v[22:25]
    v_and_b32_dpp v14, v10, v2 row_newbcast:12 row_mask:0xf bank_mask:0xf
    v_and_b32_dpp v15, v10, v3 row_newbcast:12 row_mask:0xf bank_mask:0xf
    v_and_b32_dpp v16, v10, v4 row_newbcast:12 row_mask:0xf bank_mask:0xf
    v_and_b32_dpp v17, v10, v5 row_newbcast:12 row_mask:0xf bank_mask:0xf
    s_waitcnt vmcnt(6)
    s_cbranch_vccnz L_c83
    s_waitcnt vmcnt(4)
L_c83:
    buffer_load_dwordx4 v[188:191], v1, s[12:15], s49 offen offset:3072 nt
    v_mfma_f32_16x16x32_bf16 v[22:25], v[14:17], v[160:163], v[22:25]
    v_and_b32_dpp v18, v10, v2 row_newbcast:13 row_mask:0xf bank_mask:0xf
    v_and_b32_dpp v19, v10, v3 row_newbcast:13 row_mask:0xf bank_mask:0xf
    v_and_b32_dpp v20, v10, v4 row_newbcast:13 row_mask:0xf bank_mask:0xf
    v_and_b32_dpp v21, v10, v5 row_newbcast:13 row_mask:0xf bank_mask:0xf
    s_waitcnt vmcnt(6)
    s_addk_i32 s49, 0x4000
    ds_write_b32 v46, v47 offset:288
    v_add_u32 v47, 1, v47
    ds_read_b32 v240, v241 offset:316
    s_cbranch_vccnz L_c84
    s_waitcnt vmcnt(4)
L_c84:
    buffer_load_dwordx4 v[192:195], v1, s[12:15], s49 offen nt
    v_mfma_f32_16x16x32_bf16 v[22:25], v[18:21], v[164:167], v[22:25]
    v_and_b32_dpp v14, v10, v2 row_newbcast:14 row_mask:0xf bank_mask:0xf
    v_and_b32_dpp v15, v10, v3 row_newbcast:14 row_mask:0xf bank_mask:0xf
    v_and_b32_dpp v16, v10, v4 row_newbcast:14 row_mask:0xf bank_mask:0xf
    v_and_b32_dpp v17, v10, v5 row_newbcast:14 row_mask:0xf bank_mask:0xf
    s_waitcnt vmcnt(6)
    s_waitcnt lgkmcnt(0)
    v_readfirstlane_b32 s58, v240
    s_nop 0
    s_and_b32 vcc_lo, s58, 2
    s_cbranch_vccnz L_c85
    s_waitcnt vmcnt(4)
L_c85:
    buffer_load_dwordx4 v[196:199], v1, s[12:15], s49 offen offset:1024 nt
    v_mfma_f32_16x16x32_bf16 v[22:25], v[14:17], v[168:171], v[22:25]
    v_and_b32_dpp v18, v10, v2 row_newbcast:15 row_mask:0xf bank_mask:0xf
    v_and_b32_dpp v19, v10, v3 row_newbcast:15 row_mask:0xf bank_mask:0xf
    v_and_b32_dpp v20, v10, v4 row_newbcast:15 row_mask:0xf bank_mask:0xf
    v_and_b32_dpp v21, v10, v5 row_newbcast:15 row_mask:0xf bank_mask:0xf
    s_waitcnt vmcnt(6)
    s_cbranch_vccnz L_c86
    s_waitcnt vmcnt(4)
L_c86:
    buffer_load_dwordx4 v[200:203], v1, s[12:15], s49 offen offset:2048 nt
    v_mfma_f32_16x16x32_bf16 v[22:25], v[18:21], v[172:175], v[22:25]
    v_and_b32_dpp v14, v11, v2 row_newbcast:0 row_mask:0xf bank_mask:0xf
    v_and_b32_dpp v15, v11, v3 row_newbcast:0 row_mask:0xf bank_mask:0xf
    v_and_b32_dpp v16, v11, v4 row_newbcast:0 row_mask:0xf bank_mask:0xf
    v_and_b32_dpp v17, v11, v5 row_newbcast:0 row_mask:0xf bank_mask:0xf
    s_waitcnt vmcnt(6)
    s_cbranch_vccnz L_c87
    s_waitcnt vmcnt(4)
L_c87:
    buffer_load_dwordx4 v[204:207], v1, s[12:15], s49 offen offset:3072 nt
    v_mfma_f32_16x16x32_bf16 v[22:25], v[14:17], v[176:179], v[22:25]
    v_and_b32_dpp v18, v11, v2 row_newbcast:1 row_mask:0xf bank_mask:0xf
    v_and_b32_dpp v19, v11, v3 row_newbcast:1 row_mask:0xf bank_mask:0xf
    v_and_b32_dpp v20, v11, v4 row_newbcast:1 row_mask:0xf bank_mask:0xf
    v_and_b32_dpp v21, v11, v5 row_newbcast:1 row_mask:0xf bank_mask:0xf
    s_waitcnt vmcnt(6)
    s_addk_i32 s49, 0x4000
    ds_write_b32 v46, v47 offset:288
    v_add_u32 v47, 1, v47
    ds_read_b32 v240, v241 offset:316
    s_cbranch_vccnz L_c88
    s_waitcnt vmcnt(4)
L_c88:
    buffer_load_dwordx4 v[208:211], v1, s[12:15], s49 offen nt
    v_mfma_f32_16x16x32_bf16 v[22:25], v[18:21], v[180:183], v[22:25]
    v_and_b32_dpp v14, v11, v2 row_newbcast:2 row_mask:0xf bank_mask:0xf
    v_and_b32_dpp v15, v11, v3 row_newbcast:2 row_mask:0xf bank_mask:0xf
    v_and_b32_dpp v16, v11, v4 row_newbcast:2 row_mask:0xf bank_mask:0xf
    v_and_b32_dpp v17, v11, v5 row_newbcast:2 row_mask:0xf bank_mask:0xf
    s_waitcnt vmcnt(6)
    s_waitcnt lgkmcnt(0)
    v_readfirstlane_b32 s58, v240
    s_nop 0
    s_and_b32 vcc_lo, s58, 2
    s_cbranch_vccnz L_c89
    s_waitcnt vmcnt(4)
L_c89:
    buffer_load_dwordx4 v[212:215], v1, s[12:15], s49 offen offset:1024 nt
    v_mfma_f32_16x16x32_bf16 v[22:25], v[14:17], v[184:187], v[22:25]
    v_and_b32_dpp v18, v11, v2 row_newbcast:3 row_mask:0xf bank_mask:0xf
    v_and_b32_dpp v19, v11, v3 row_newbcast:3 row_mask:0xf bank_mask:0xf
    v_and_b32_dpp v20, v11, v4 row_newbcast:3 row_mask:0xf bank_mask:0xf
    v_and_b32_dpp v21, v11, v5 row_newbcast:3 row_mask:0xf bank_mask:0xf
    s_waitcnt vmcnt(6)
    s_cbranch_vccnz L_c90
    s_waitcnt vmcnt(4)
L_c90:
    buffer_load_dwordx4 v[216:219], v1, s[12:15], s49 offen offset:2048 nt
    v_mfma_f32_16x16x32_bf16 v[22:25], v[18:21], v[188:191], v[22:25]
    v_and_b32_dpp v14, v11, v2 row_newbcast:4 row_mask:0xf bank_mask:0xf
    v_and_b32_dpp v15, v11, v3 row_newbcast:4 row_mask:0xf bank_mask:0xf
    v_and_b32_dpp v16, v11, v4 row_newbcast:4 row_mask:0xf bank_mask:0xf
    v_and_b32_dpp v17, v11, v5 row_newbcast:4 row_mask:0xf bank_mask:0xf
    s_waitcnt vmcnt(6)
    s_cbranch_vccnz L_c91
    s_waitcnt vmcnt(4)
L_c91:
    buffer_load_dwordx4 v[220:223], v1, s[12:15], s49 offen offset:3072 nt
    v_mfma_f32_16x16x32_bf16 v[22:25], v[14:17], v[192:195], v[22:25]
    v_and_b32_dpp v18, v11, v2 row_newbcast:5 row_mask:0xf bank_mask:0xf
    v_and_b32_dpp v19, v11, v3 row_newbcast:5 row_mask:0xf bank_mask:0xf
    v_and_b32_dpp v20, v11, v4 row_newbcast:5 row_mask:0xf bank_mask:0xf
    v_and_b32_dpp v21, v11, v5 row_newbcast:5 row_mask:0xf bank_mask:0xf
    s_waitcnt vmcnt(6)
    s_addk_i32 s49, 0x4000
    ds_write_b32 v46, v47 offset:288
    v_add_u32 v47, 1, v47
    ds_read_b32 v240, v241 offset:316
    s_cbranch_vccnz L_c92
    s_waitcnt vmcnt(4)
L_c92:
    buffer_load_dwordx4 v[224:227], v1, s[12:15], s49 offen nt
    v_mfma_f32_16x16x32_bf16 v[22:25], v[18:21], v[196:199], v[22:25]
    v_and_b32_dpp v14, v11, v2 row_newbcast:6 row_mask:0xf bank_mask:0xf
    v_and_b32_dpp v15, v11, v3 row_newbcast:6 row_mask:0xf bank_mask:0xf
    v_and_b32_dpp v16, v11, v4 row_newbcast:6 row_mask:0xf bank_mask:0xf
    v_and_b32_dpp v17, v11, v5 row_newbcast:6 row_mask:0xf bank_mask:0xf
    s_waitcnt vmcnt(6)
    s_waitcnt lgkmcnt(0)
    v_readfirstlane_b32 s58, v240
    s_nop 0
    s_and_b32 vcc_lo, s58, 2
    s_cbranch_vccnz L_c93
    s_waitcnt vmcnt(4)
L_c93:
    buffer_load_dwordx4 v[228:231], v1, s[12:15], s49 offen offset:1024 nt
    v_mfma_f32_16x16x32_bf16 v[22:25], v[14:17], v[200:203], v[22:25]
    v_and_b32_dpp v18, v11, v2 row_newbcast:7 row_mask:0xf bank_mask:0xf
    v_and_b32_dpp v19, v11, v3 row_newbcast:7 row_mask:0xf bank_mask:0xf
    v_and_b32_dpp v20, v11, v4 row_newbcast:7 row_mask:0xf bank_mask:0xf
    v_and_b32_dpp v21, v11, v5 row_newbcast:7 row_mask:0xf bank_mask:0xf
    s_waitcnt vmcnt(6)
    s_cbranch_vccnz L_c94
    s_waitcnt vmcnt(4)
L_c94:
    buffer_load_dwordx4 v[232:235], v1, s[12:15], s49 offen offset:2048 nt
    v_mfma_f32_16x16x32_bf16 v[22:25], v[18:21], v[204:207], v[22:25]
    v_and_b32_dpp v14, v11, v2 row_newbcast:8 row_mask:0xf bank_mask:0xf
    v_and_b32_dpp v15, v11, v3 row_newbcast:8 row_mask:0xf bank_mask:0xf
    v_and_b32_dpp v16, v11, v4 row_newbcast:8 row_mask:0xf bank_mask:0xf
    v_and_b32_dpp v17, v11, v5 row_newbcast:8 row_mask:0xf bank_mask:0xf
    s_waitcnt vmcnt(6)
    s_cbranch_vccnz L_c95
    s_waitcnt vmcnt(4)
L_c95:
    buffer_load_dwordx4 v[236:239], v1, s[12:15], s49 offen offset:3072 nt
    v_mfma_f32_16x16x32_bf16 v[22:25], v[14:17], v[208:211], v[22:25]
    v_and_b32_dpp v18, v11, v2 row_newbcast:9 row_mask:0xf bank_mask:0xf
    v_and_b32_dpp v19, v11, v3 row_newbcast:9 row_mask:0xf bank_mask:0xf
    v_and_b32_dpp v20, v11, v4 row_newbcast:9 row_mask:0xf bank_mask:0xf
    v_and_b32_dpp v21, v11, v5 row_newbcast:9 row_mask:0xf bank_mask:0xf
    s_waitcnt vmcnt(6)
    s_addk_i32 s49, 0x4000
    ds_write_b32 v46, v47 offset:288
    v_add_u32 v47, 1, v47
    ds_read_b32 v240, v241 offset:316
    s_cbranch_vccnz L_c96
    s_waitcnt vmcnt(4)
L_c96:
    buffer_load_dwordx4 v[48:51], v1, s[12:15], s49 offen nt
    v_mfma_f32_16x16x32_bf16 v[22:25], v[18:21], v[212:215], v[22:25]
    v_and_b32_dpp v14, v11, v2 row_newbcast:10 row_mask:0xf bank_mask:0xf
    v_and_b32_dpp v15, v11, v3 row_newbcast:10 row_mask:0xf bank_mask:0xf
    v_and_b32_dpp v16, v11, v4 row_newbcast:10 row_mask:0xf bank_mask:0xf
    v_and_b32_dpp v17, v11, v5 row_newbcast:10 row_mask:0xf bank_mask:0xf
    s_waitcnt vmcnt(6)
    s_waitcnt lgkmcnt(0)
    v_readfirstlane_b32 s58, v240
    s_nop 0
    s_and_b32 vcc_lo, s58, 2
    s_cbranch_vccnz L_c97
    s_waitcnt vmcnt(4)
L_c97:
    buffer_load_dwordx4 v[52:55], v1, s[12:15], s49 offen offset:1024 nt
    v_mfma_f32_16x16x32_bf16 v[22:25], v[14:17], v[216:219], v[22:25]
    v_and_b32_dpp v18, v11, v2 row_newbcast:11 row_mask:0xf bank_mask:0xf
    v_and_b32_dpp v19, v11, v3 row_newbcast:11 row_mask:0xf bank_mask:0xf
    v_and_b32_dpp v20, v11, v4 row_newbcast:11 row_mask:0xf bank_mask:0xf
    v_and_b32_dpp v21, v11, v5 row_newbcast:11 row_mask:0xf bank_mask:0xf
    s_waitcnt vmcnt(6)
    s_cbranch_vccnz L_c98
    s_waitcnt vmcnt(4)
L_c98:
    buffer_load_dwordx4 v[56:59], v1, s[12:15], s49 offen offset:2048 nt
    v_mfma_f32_16x16x32_bf16 v[22:25], v[18:21], v[220:223], v[22:25]
    v_and_b32_dpp v14, v11, v2 row_newbcast:12 row_mask:0xf bank_mask:0xf
    v_and_b32_dpp v15, v11, v3 row_newbcast:12 row_mask:0xf bank_mask:0xf
    v_and_b32_dpp v16, v11, v4 row_newbcast:12 row_mask:0xf bank_mask:0xf
    v_and_b32_dpp v17, v11, v5 row_newbcast:12 row_mask:0xf bank_mask:0xf
    s_waitcnt vmcnt(6)
    s_cbranch_vccnz L_c99
    s_waitcnt vmcnt(4)
L_c99:
    buffer_load_dwordx4 v[60:63], v1, s[12:15], s49 offen offset:3072 nt
    v_mfma_f32_16x16x32_bf16 v[22:25], v[14:17], v[224:227], v[22:25]
    v_and_b32_dpp v18, v11, v2 row_newbcast:13 row_mask:0xf bank_mask:0xf
    v_and_b32_dpp v19, v11, v3 row_newbcast:13 row_mask:0xf bank_mask:0xf
    v_and_b32_dpp v20, v11, v4 row_newbcast:13 row_mask:0xf bank_mask:0xf
    v_and_b32_dpp v21, v11, v5 row_newbcast:13 row_mask:0xf bank_mask:0xf
    s_waitcnt vmcnt(6)
    s_addk_i32 s49, 0x4000
    ds_write_b32 v46, v47 offset:288
    v_add_u32 v47, 1, v47
    ds_read_b32 v240, v241 offset:316
    s_cbranch_vccnz L_c100
    s_waitcnt vmcnt(4)
L_c100:
    buffer_load_dwordx4 v[64:67], v1, s[12:15], s49 offen nt
    v_mfma_f32_16x16x32_bf16 v[22:25], v[18:21], v[228:231], v[22:25]
    v_and_b32_dpp v14, v11, v2 row_newbcast:14 row_mask:0xf bank_mask:0xf
    v_and_b32_dpp v15, v11, v3 row_newbcast:14 row_mask:0xf bank_mask:0xf
    v_and_b32_dpp v16, v11, v4 row_newbcast:14 row_mask:0xf bank_mask:0xf
    v_and_b32_dpp v17, v11, v5 row_newbcast:14 row_mask:0xf bank_mask:0xf
    s_waitcnt vmcnt(6)
    s_waitcnt lgkmcnt(0)
    v_readfirstlane_b32 s58, v240
    s_nop 0
    s_and_b32 vcc_lo, s58, 2
    s_cbranch_vccnz L_c101
    s_waitcnt vmcnt(4)
L_c101:
    buffer_load_dwordx4 v[68:71], v1, s[12:15], s49 offen offset:1024 nt
    v_mfma_f32_16x16x32_bf16 v[22:25], v[14:17], v[232:235], v[22:25]
    v_and_b32_dpp v18, v11, v2 row_newbcast:15 row_mask:0xf bank_mask:0xf
    v_and_b32_dpp v19, v11, v3 row_newbcast:15 row_mask:0xf bank_mask:0xf
    v_and_b32_dpp v20, v11, v4 row_newbcast:15 row_mask:0xf bank_mask:0xf
    v_and_b32_dpp v21, v11, v5 row_newbcast:15 row_mask:0xf bank_mask:0xf
    s_waitcnt vmcnt(6)
    s_cbranch_vccnz L_c102
    s_waitcnt vmcnt(4)
L_c102:
    buffer_load_dwordx4 v[72:75], v1, s[12:15], s49 offen offset:2048 nt
    v_mfma_f32_16x16x32_bf16 v[22:25], v[18:21], v[236:239], v[22:25]
    v_and_b32_dpp v14, v12, v2 row_newbcast:0 row_mask:0xf bank_mask:0xf
    v_and_b32_dpp v15, v12, v3 row_newbcast:0 row_mask:0xf bank_mask:0xf
    v_and_b32_dpp v16, v12, v4 row_newbcast:0 row_mask:0xf bank_mask:0xf
    v_and_b32_dpp v17, v12, v5 row_newbcast:0 row_mask:0xf bank_mask:0xf
    s_waitcnt vmcnt(6)
    s_cbranch_vccnz L_c103
    s_waitcnt vmcnt(4)
L_c103:
    buffer_load_dwordx4 v[76:79], v1, s[12:15], s49 offen offset:3072 nt
    v_mfma_f32_16x16x32_bf16 v[22:25], v[14:17], v[48:51], v[22:25]
    v_and_b32_dpp v18, v12, v2 row_newbcast:1 row_mask:0xf bank_mask:0xf
    v_and_b32_dpp v19, v12, v3 row_newbcast:1 row_mask:0xf bank_mask:0xf
    v_and_b32_dpp v20, v12, v4 row_newbcast:1 row_mask:0xf bank_mask:0xf
    v_and_b32_dpp v21, v12, v5 row_newbcast:1 row_mask:0xf bank_mask:0xf
    s_waitcnt vmcnt(6)
    s_addk_i32 s49, 0x4000
    ds_write_b32 v46, v47 offset:288
    v_add_u32 v47, 1, v47
    ds_read_b32 v240, v241 offset:316
    s_cbranch_vccnz L_c104
    s_waitcnt vmcnt(4)
L_c104:
    buffer_load_dwordx4 v[80:83], v1, s[12:15], s49 offen nt
    v_mfma_f32_16x16x32_bf16 v[22:25], v[18:21], v[52:55], v[22:25]
    v_and_b32_dpp v14, v12, v2 row_newbcast:2 row_mask:0xf bank_mask:0xf
    v_and_b32_dpp v15, v12, v3 row_newbcast:2 row_mask:0xf bank_mask:0xf
    v_and_b32_dpp v16, v12, v4 row_newbcast:2 row_mask:0xf bank_mask:0xf
    v_and_b32_dpp v17, v12, v5 row_newbcast:2 row_mask:0xf bank_mask:0xf
    s_waitcnt vmcnt(6)
    s_waitcnt lgkmcnt(0)
    v_readfirstlane_b32 s58, v240
    s_nop 0
    s_and_b32 vcc_lo, s58, 2
    s_cbranch_vccnz L_c105
    s_waitcnt vmcnt(4)
L_c105:
    buffer_load_dwordx4 v[84:87], v1, s[12:15], s49 offen offset:1024 nt
    v_mfma_f32_16x16x32_bf16 v[22:25], v[14:17], v[56:59], v[22:25]
    v_and_b32_dpp v18, v12, v2 row_newbcast:3 row_mask:0xf bank_mask:0xf
    v_and_b32_dpp v19, v12, v3 row_newbcast:3 row_mask:0xf bank_mask:0xf
    v_and_b32_dpp v20, v12, v4 row_newbcast:3 row_mask:0xf bank_mask:0xf
    v_and_b32_dpp v21, v12, v5 row_newbcast:3 row_mask:0xf bank_mask:0xf
    s_waitcnt vmcnt(6)
    s_cbranch_vccnz L_c106
    s_waitcnt vmcnt(4)
L_c106:
    buffer_load_dwordx4 v[88:91], v1, s[12:15], s49 offen offset:2048 nt
    v_mfma_f32_16x16x32_bf16 v[22:25], v[18:21], v[60:63], v[22:25]
    v_and_b32_dpp v14, v12, v2 row_newbcast:4 row_mask:0xf bank_mask:0xf
    v_and_b32_dpp v15, v12, v3 row_newbcast:4 row_mask:0xf bank_mask:0xf
    v_and_b32_dpp v16, v12, v4 row_newbcast:4 row_mask:0xf bank_mask:0xf
    v_and_b32_dpp v17, v12, v5 row_newbcast:4 row_mask:0xf bank_mask:0xf
    s_waitcnt vmcnt(6)
    s_cbranch_vccnz L_c107
    s_waitcnt vmcnt(4)
L_c107:
    buffer_load_dwordx4 v[92:95], v1, s[12:15], s49 offen offset:3072 nt
    v_mfma_f32_16x16x32_bf16 v[22:25], v[14:17], v[64:67], v[22:25]
    v_and_b32_dpp v18, v12, v2 row_newbcast:5 row_mask:0xf bank_mask:0xf
    v_and_b32_dpp v19, v12, v3 row_newbcast:5 row_mask:0xf bank_mask:0xf
    v_and_b32_dpp v20, v12, v4 row_newbcast:5 row_mask:0xf bank_mask:0xf
    v_and_b32_dpp v21, v12, v5 row_newbcast:5 row_mask:0xf bank_mask:0xf
    ds_write_b32 v43, v47 offset:312
    s_waitcnt vmcnt(6)
    s_addk_i32 s49, 0x4000
    ds_write_b32 v46, v47 offset:288
    v_add_u32 v47, 1, v47
    ds_read_b32 v240, v241 offset:316
    s_cbranch_vccnz L_c108
    s_waitcnt vmcnt(4)
L_c108:
    buffer_load_dwordx4 v[96:99], v1, s[12:15], s49 offen nt
    v_mfma_f32_16x16x32_bf16 v[22:25], v[18:21], v[68:71], v[22:25]
    v_and_b32_dpp v14, v12, v2 row_newbcast:6 row_mask:0xf bank_mask:0xf
    v_and_b32_dpp v15, v12, v3 row_newbcast:6 row_mask:0xf bank_mask:0xf
    v_and_b32_dpp v16, v12, v4 row_newbcast:6 row_mask:0xf bank_mask:0xf
    v_and_b32_dpp v17, v12, v5 row_newbcast:6 row_mask:0xf bank_mask:0xf
    s_waitcnt vmcnt(6)
    s_waitcnt lgkmcnt(0)
    v_readfirstlane_b32 s58, v240
    s_nop 0
    s_and_b32 vcc_lo, s58, 2
    s_cbranch_vccnz L_c109
    s_waitcnt vmcnt(4)
L_c109:
    buffer_load_dwordx4 v[100:103], v1, s[12:15], s49 offen offset:1024 nt
    v_mfma_f32_16x16x32_bf16 v[22:25], v[14:17], v[72:75], v[22:25]
    v_and_b32_dpp v18, v12, v2 row_newbcast:7 row_mask:0xf bank_mask:0xf
    v_and_b32_dpp v19, v12, v3 row_newbcast:7 row_mask:0xf bank_mask:0xf
    v_and_b32_dpp v20, v12, v4 row_newbcast:7 row_mask:0xf bank_mask:0xf
    v_and_b32_dpp v21, v12, v5 row_newbcast:7 row_mask:0xf bank_mask:0xf
    s_waitcnt vmcnt(6)
    s_cbranch_vccnz L_c110
    s_waitcnt vmcnt(4)
L_c110:
    buffer_load_dwordx4 v[104:107], v1, s[12:15], s49 offen offset:2048 nt
    v_mfma_f32_16x16x32_bf16 v[22:25], v[18:21], v[76:79], v[22:25]
    v_and_b32_dpp v14, v12, v2 row_newbcast:8 row_mask:0xf bank_mask:0xf
    v_and_b32_dpp v15, v12, v3 row_newbcast:8 row_mask:0xf bank_mask:0xf
    v_and_b32_dpp v16, v12, v4 row_newbcast:8 row_mask:0xf bank_mask:0xf
    v_and_b32_dpp v17, v12, v5 row_newbcast:8 row_mask:0xf bank_mask:0xf
    s_waitcnt vmcnt(6)
    s_cbranch_vccnz L_c111
    s_waitcnt vmcnt(4)
L_c111:
    buffer_load_dwordx4 v[108:111], v1, s[12:15], s49 offen offset:3072 nt
    v_mfma_f32_16x16x32_bf16 v[22:25], v[14:17], v[80:83], v[22:25]
    v_and_b32_dpp v18, v12, v2 row_newbcast:9 row_mask:0xf bank_mask:0xf
    v_and_b32_dpp v19, v12, v3 row_newbcast:9 row_mask:0xf bank_mask:0xf
    v_and_b32_dpp v20, v12, v4 row_newbcast:9 row_mask:0xf bank_mask:0xf
    v_and_b32_dpp v21, v12, v5 row_newbcast:9 row_mask:0xf bank_mask:0xf
    s_addk_i32 s49, 0x4000
    s_waitcnt vmcnt(6)
    s_cbranch_vccnz L_c112
    s_waitcnt vmcnt(4)
L_c112:
    buffer_load_dwordx4 v[112:115], v1, s[12:15], s49 offen nt
    v_mfma_f32_16x16x32_bf16 v[22:25], v[18:21], v[84:87], v[22:25]
    v_and_b32_dpp v14, v12, v2 row_newbcast:10 row_mask:0xf bank_mask:0xf
    v_and_b32_dpp v15, v12, v3 row_newbcast:10 row_mask:0xf bank_mask:0xf
    v_and_b32_dpp v16, v12, v4 row_newbcast:10 row_mask:0xf bank_mask:0xf
    v_and_b32_dpp v17, v12, v5 row_newbcast:10 row_mask:0xf bank_mask:0xf
    s_waitcnt vmcnt(6)
    s_cbranch_vccnz L_c113
    s_waitcnt vmcnt(4)
L_c113:
    buffer_load_dwordx4 v[116:119], v1, s[12:15], s49 offen offset:1024 nt
    v_mfma_f32_16x16x32_bf16 v[22:25], v[14:17], v[88:91], v[22:25]
    v_and_b32_dpp v18, v12, v2 row_newbcast:11 row_mask:0xf bank_mask:0xf
    v_and_b32_dpp v19, v12, v3 row_newbcast:11 row_mask:0xf bank_mask:0xf
    v_and_b32_dpp v20, v12, v4 row_newbcast:11 row_mask:0xf bank_mask:0xf
    v_and_b32_dpp v21, v12, v5 row_newbcast:11 row_mask:0xf bank_mask:0xf
    s_waitcnt vmcnt(6)
    s_cbranch_vccnz L_c114
    s_waitcnt vmcnt(4)
L_c114:
    buffer_load_dwordx4 v[120:123], v1, s[12:15], s49 offen offset:2048 nt
    v_mfma_f32_16x16x32_bf16 v[22:25], v[18:21], v[92:95], v[22:25]
    v_and_b32_dpp v14, v12, v2 row_newbcast:12 row_mask:0xf bank_mask:0xf
    v_and_b32_dpp v15, v12, v3 row_newbcast:12 row_mask:0xf bank_mask:0xf
    v_and_b32_dpp v16, v12, v4 row_newbcast:12 row_mask:0xf bank_mask:0xf
    v_and_b32_dpp v17, v12, v5 row_newbcast:12 row_mask:0xf bank_mask:0xf
    s_waitcnt vmcnt(6)
    s_cbranch_vccnz L_c115
    s_waitcnt vmcnt(4)
L_c115:
    buffer_load_dwordx4 v[124:127], v1, s[12:15], s49 offen offset:3072 nt
    s_addk_i32 s49, 0x4000
    buffer_load_dwordx4 v[128:131], v1, s[12:15], s49 offen nt
    v_mfma_f32_16x16x32_bf16 v[22:25], v[14:17], v[96:99], v[22:25]
    v_and_b32_dpp v18, v12, v2 row_newbcast:13 row_mask:0xf bank_mask:0xf
    v_and_b32_dpp v19, v12, v3 row_newbcast:13 row_mask:0xf bank_mask:0xf
    v_and_b32_dpp v20, v12, v4 row_newbcast:13 row_mask:0xf bank_mask:0xf
    v_and_b32_dpp v21, v12, v5 row_newbcast:13 row_mask:0xf bank_mask:0xf
    s_waitcnt vmcnt(7)
    buffer_load_dwordx4 v[132:135], v1, s[12:15], s49 offen offset:1024 nt
    v_mfma_f32_16x16x32_bf16 v[22:25], v[18:21], v[100:103], v[22:25]
    v_and_b32_dpp v14, v12, v2 row_newbcast:14 row_mask:0xf bank_mask:0xf
    v_and_b32_dpp v15, v12, v3 row_newbcast:14 row_mask:0xf bank_mask:0xf
    v_and_b32_dpp v16, v12, v4 row_newbcast:14 row_mask:0xf bank_mask:0xf
    v_and_b32_dpp v17, v12, v5 row_newbcast:14 row_mask:0xf bank_mask:0xf
    s_waitcnt vmcnt(7)
    buffer_load_dwordx4 v[136:139], v1, s[12:15], s49 offen offset:2048 nt
    v_mfma_f32_16x16x32_bf16 v[22:25], v[14:17], v[104:107], v[22:25]
    v_and_b32_dpp v18, v12, v2 row_newbcast:15 row_mask:0xf bank_mask:0xf
    v_and_b32_dpp v19, v12, v3 row_newbcast:15 row_mask:0xf bank_mask:0xf
    v_and_b32_dpp v20, v12, v4 row_newbcast:15 row_mask:0xf bank_mask:0xf
    v_and_b32_dpp v21, v12, v5 row_newbcast:15 row_mask:0xf bank_mask:0xf
    s_waitcnt vmcnt(7)
    buffer_load_dwordx4 v[140:143], v1, s[12:15], s49 offen offset:3072 nt
    v_mfma_f32_16x16x32_bf16 v[22:25], v[18:21], v[108:111], v[22:25]
    v_and_b32_dpp v14, v13, v2 row_newbcast:0 row_mask:0xf bank_mask:0xf
    v_and_b32_dpp v15, v13, v3 row_newbcast:0 row_mask:0xf bank_mask:0xf
    v_and_b32_dpp v16, v13, v4 row_newbcast:0 row_mask:0xf bank_mask:0xf
    v_and_b32_dpp v17, v13, v5 row_newbcast:0 row_mask:0xf bank_mask:0xf
    s_waitcnt vmcnt(7)
    s_addk_i32 s49, 0x4000
    buffer_load_dwordx4 v[144:147], v1, s[12:15], s49 offen nt
    v_mfma_f32_16x16x32_bf16 v[22:25], v[14:17], v[112:115], v[22:25]
    v_and_b32_dpp v18, v13, v2 row_newbcast:1 row_mask:0xf bank_mask:0xf
    v_and_b32_dpp v19, v13, v3 row_newbcast:1 row_mask:0xf bank_mask:0xf
    v_and_b32_dpp v20, v13, v4 row_newbcast:1 row_mask:0xf bank_mask:0xf
    v_and_b32_dpp v21, v13, v5 row_newbcast:1 row_mask:0xf bank_mask:0xf
    s_waitcnt vmcnt(7)
    buffer_load_dwordx4 v[148:151], v1, s[12:15], s49 offen offset:1024 nt
    v_mfma_f32_16x16x32_bf16 v[22:25], v[18:21], v[116:119], v[22:25]
    v_and_b32_dpp v14, v13, v2 row_newbcast:2 row_mask:0xf bank_mask:0xf
    v_and_b32_dpp v15, v13, v3 row_newbcast:2 row_mask:0xf bank_mask:0xf
    v_and_b32_dpp v16, v13, v4 row_newbcast:2 row_mask:0xf bank_mask:0xf
    v_and_b32_dpp v17, v13, v5 row_newbcast:2 row_mask:0xf bank_mask:0xf
    s_waitcnt vmcnt(7)
    buffer_load_dwordx4 v[152:155], v1, s[12:15], s49 offen offset:2048 nt
    v_mfma_f32_16x16x32_bf16 v[22:25], v[14:17], v[120:123], v[22:25]
    v_and_b32_dpp v18, v13, v2 row_newbcast:3 row_mask:0xf bank_mask:0xf
    v_and_b32_dpp v19, v13, v3 row_newbcast:3 row_mask:0xf bank_mask:0xf
    v_and_b32_dpp v20, v13, v4 row_newbcast:3 row_mask:0xf bank_mask:0xf
    v_and_b32_dpp v21, v13, v5 row_newbcast:3 row_mask:0xf bank_mask:0xf
    s_waitcnt vmcnt(7)
    buffer_load_dwordx4 v[156:159], v1, s[12:15], s49 offen offset:3072 nt
    v_mfma_f32_16x16x32_bf16 v[22:25], v[18:21], v[124:127], v[22:25]
    v_and_b32_dpp v14, v13, v2 row_newbcast:4 row_mask:0xf bank_mask:0xf
    v_and_b32_dpp v15, v13, v3 row_newbcast:4 row_mask:0xf bank_mask:0xf
    v_and_b32_dpp v16, v13, v4 row_newbcast:4 row_mask:0xf bank_mask:0xf
    v_and_b32_dpp v17, v13, v5 row_newbcast:4 row_mask:0xf bank_mask:0xf
    s_waitcnt vmcnt(7)
    s_addk_i32 s49, 0x4000
    buffer_load_dwordx4 v[160:163], v1, s[12:15], s49 offen nt
    v_mfma_f32_16x16x32_bf16 v[22:25], v[14:17], v[128:131], v[22:25]
    v_and_b32_dpp v18, v13, v2 row_newbcast:5 row_mask:0xf bank_mask:0xf
    v_and_b32_dpp v19, v13, v3 row_newbcast:5 row_mask:0xf bank_mask:0xf
    v_and_b32_dpp v20, v13, v4 row_newbcast:5 row_mask:0xf bank_mask:0xf
    v_and_b32_dpp v21, v13, v5 row_newbcast:5 row_mask:0xf bank_mask:0xf
    s_waitcnt vmcnt(7)
    buffer_load_dwordx4 v[164:167], v1, s[12:15], s49 offen offset:1024 nt
    v_mfma_f32_16x16x32_bf16 v[22:25], v[18:21], v[132:135], v[22:25]
    v_and_b32_dpp v14, v13, v2 row_newbcast:6 row_mask:0xf bank_mask:0xf
    v_and_b32_dpp v15, v13, v3 row_newbcast:6 row_mask:0xf bank_mask:0xf
    v_and_b32_dpp v16, v13, v4 row_newbcast:6 row_mask:0xf bank_mask:0xf
    v_and_b32_dpp v17, v13, v5 row_newbcast:6 row_mask:0xf bank_mask:0xf
    s_waitcnt vmcnt(7)
    buffer_load_dwordx4 v[168:171], v1, s[12:15], s49 offen offset:2048 nt
    v_mfma_f32_16x16x32_bf16 v[22:25], v[14:17], v[136:139], v[22:25]
    v_and_b32_dpp v18, v13, v2 row_newbcast:7 row_mask:0xf bank_mask:0xf
    v_and_b32_dpp v19, v13, v3 row_newbcast:7 row_mask:0xf bank_mask:0xf
    v_and_b32_dpp v20, v13, v4 row_newbcast:7 row_mask:0xf bank_mask:0xf
    v_and_b32_dpp v21, v13, v5 row_newbcast:7 row_mask:0xf bank_mask:0xf
    s_waitcnt vmcnt(7)
    buffer_load_dwordx4 v[172:175], v1, s[12:15], s49 offen offset:3072 nt
    v_mfma_f32_16x16x32_bf16 v[22:25], v[18:21], v[140:143], v[22:25]
    v_and_b32_dpp v14, v13, v2 row_newbcast:8 row_mask:0xf bank_mask:0xf
    v_and_b32_dpp v15, v13, v3 row_newbcast:8 row_mask:0xf bank_mask:0xf
    v_and_b32_dpp v16, v13, v4 row_newbcast:8 row_mask:0xf bank_mask:0xf
    v_and_b32_dpp v17, v13, v5 row_newbcast:8 row_mask:0xf bank_mask:0xf
    s_waitcnt vmcnt(7)
    s_nop 0
    v_mfma_f32_16x16x32_bf16 v[22:25], v[14:17], v[144:147], v[22:25]
    v_and_b32_dpp v18, v13, v2 row_newbcast:9 row_mask:0xf bank_mask:0xf
    v_and_b32_dpp v19, v13, v3 row_newbcast:9 row_mask:0xf bank_mask:0xf
    v_and_b32_dpp v20, v13, v4 row_newbcast:9 row_mask:0xf bank_mask:0xf
    v_and_b32_dpp v21, v13, v5 row_newbcast:9 row_mask:0xf bank_mask:0xf
    s_waitcnt vmcnt(6)
    s_nop 0
    v_mfma_f32_16x16x32_bf16 v[22:25], v[18:21], v[148:151], v[22:25]
    v_and_b32_dpp v14, v13, v2 row_newbcast:10 row_mask:0xf bank_mask:0xf
    v_and_b32_dpp v15, v13, v3 row_newbcast:10 row_mask:0xf bank_mask:0xf
    v_and_b32_dpp v16, v13, v4 row_newbcast:10 row_mask:0xf bank_mask:0xf
    v_and_b32_dpp v17, v13, v5 row_newbcast:10 row_mask:0xf bank_mask:0xf
    s_waitcnt vmcnt(5)
    s_nop 0
    v_mfma_f32_16x16x32_bf16 v[22:25], v[14:17], v[152:155], v[22:25]
    v_and_b32_dpp v18, v13, v2 row_newbcast:11 row_mask:0xf bank_mask:0xf
    v_and_b32_dpp v19, v13, v3 row_newbcast:11 row_mask:0xf bank_mask:0xf
    v_and_b32_dpp v20, v13, v4 row_newbcast:11 row_mask:0xf bank_mask:0xf
    v_and_b32_dpp v21, v13, v5 row_newbcast:11 row_mask:0xf bank_mask:0xf
    ds_write_b32 v43, v47 offset:308
    s_waitcnt vmcnt(4)
    v_mfma_f32_16x16x32_bf16 v[22:25], v[18:21], v[156:159], v[22:25]
    v_and_b32_dpp v14, v13, v2 row_newbcast:12 row_mask:0xf bank_mask:0xf
    v_and_b32_dpp v15, v13, v3 row_newbcast:12 row_mask:0xf bank_mask:0xf
    v_and_b32_dpp v16, v13, v4 row_newbcast:12 row_mask:0xf bank_mask:0xf
    v_and_b32_dpp v17, v13, v5 row_newbcast:12 row_mask:0xf bank_mask:0xf
    s_waitcnt vmcnt(3)
    s_nop 0
    v_mfma_f32_16x16x32_bf16 v[22:25], v[14:17], v[160:163], v[22:25]
    v_and_b32_dpp v18, v13, v2 row_newbcast:13 row_mask:0xf bank_mask:0xf
    v_and_b32_dpp v19, v13, v3 row_newbcast:13 row_mask:0xf bank_mask:0xf
    v_and_b32_dpp v20, v13, v4 row_newbcast:13 row_mask:0xf bank_mask:0xf
    v_and_b32_dpp v21, v13, v5 row_newbcast:13 row_mask:0xf bank_mask:0xf
    s_waitcnt vmcnt(2)
    s_nop 0
    v_mfma_f32_16x16x32_bf16 v[22:25], v[18:21], v[164:167], v[22:25]
    v_and_b32_dpp v14, v13, v2 row_newbcast:14 row_mask:0xf bank_mask:0xf
    v_and_b32_dpp v15, v13, v3 row_newbcast:14 row_mask:0xf bank_mask:0xf
    v_and_b32_dpp v16, v13, v4 row_newbcast:14 row_mask:0xf bank_mask:0xf
    v_and_b32_dpp v17, v13, v5 row_newbcast:14 row_mask:0xf bank_mask:0xf
    s_waitcnt vmcnt(1)
    s_nop 0
    v_mfma_f32_16x16x32_bf16 v[22:25], v[14:17], v[168:171], v[22:25]
    v_and_b32_dpp v18, v13, v2 row_newbcast:15 row_mask:0xf bank_mask:0xf
    v_and_b32_dpp v19, v13, v3 row_newbcast:15 row_mask:0xf bank_mask:0xf
    v_and_b32_dpp v20, v13, v4 row_newbcast:15 row_mask:0xf bank_mask:0xf
    v_and_b32_dpp v21, v13, v5 row_newbcast:15 row_mask:0xf bank_mask:0xf
    s_waitcnt vmcnt(0)
    s_nop 0
    v_mfma_f32_16x16x32_bf16 v[22:25], v[18:21], v[172:175], v[22:25]
    s_mov_b32 exec_hi, 0
    s_nop 6
    ds_write_b128 v42, v[22:25] offset:1024
    s_waitcnt lgkmcnt(0)
    s_barrier
    s_endpgm
L_claim:
    s_load_dwordx2 s[40:41], s[0:1], 88
    s_mov_b32 s42, 268435456
    s_mov_b32 s43, 0x20000
    s_and_b32 s52, s2, 7
    s_lshl_b32 s52, s52, 7
    s_add_u32 s48, s52, 2097152
    s_lshr_b32 s51, s2, 3
    s_lshl_b32 s53, s51, 2
    v_mov_b32 v1, 0
    v_mov_b32 v3, s53
    v_and_b32 v2, 31, v0
    v_lshlrev_b32 v2, 2, v2
    s_mov_b32 s49, 0
    s_barrier
    s_mov_b32 s57, 16777216
L_baltag:
    s_sleep 4
    ds_read_b32 v8, v1 offset:592
    s_sub_u32 s57, s57, 1
    s_cbranch_scc1 L_bal_end
    s_waitcnt lgkmcnt(0)
    v_cmp_eq_u32 vcc, 0, v8
    v_and_b32 v8, 0xffffffe0, v8
    s_nop 0
    s_cbranch_vccnz L_baltag
L_bal:
    s_mov_b32 s57, 16777216
L_balw:
    s_sleep 1
    ds_read_b128 v[4:7], v1 offset:288
    s_sub_u32 s57, s57, 1
    s_cbranch_scc1 L_bal_end
    s_waitcnt lgkmcnt(0)
    v_min3_u32 v4, v4, v5, v6
    v_min_u32 v4, v4, v7
    s_nop 0
    v_readfirstlane_b32 s53, v4
    s_nop 0
    s_cmp_le_u32 s53, s49
    s_cbranch_scc1 L_balw
    s_mov_b32 s49, s53
    v_or_b32 v6, v4, v8
    s_mov_b64 exec, 1
    buffer_store_dword v6, v3, s[40:43], s48 offen
    s_mov_b64 exec, -1
    buffer_load_dword v5, v2, s[40:43], s48 offen sc1
    s_waitcnt vmcnt(0)
    v_xor_b32 v5, v5, v8
    v_cmp_gt_u32 vcc, 32, v5
    s_nop 1
    v_cndmask_b32 v5, v4, v5, vcc
    s_nop 1
    v_add_u32_dpp v5, v5, v5 quad_perm:[1,0,3,2] row_mask:0xf bank_mask:0xf
    s_nop 1
    v_add_u32_dpp v5, v5, v5 quad_perm:[2,3,0,1] row_mask:0xf bank_mask:0xf
    s_nop 1
    v_add_u32_dpp v5, v5, v5 row_half_mirror row_mask:0xf bank_mask:0xf
    s_nop 1
    v_add_u32_dpp v5, v5, v5 row_mirror row_mask:0xf bank_mask:0xf
    s_nop 1
    v_add_u32_dpp v5, v5, v5 row_bcast:15 row_mask:0xa bank_mask:0xf
    s_nop 0
    v_readlane_b32 s60, v5, 31
    s_lshl_b32 s54, s49, 5
    s_sub_i32 s55, s60, s54
    s_mov_b32 s56, 0
    s_cmp_gt_i32 s55, 2
    s_cselect_b32 s56, 2, s56
    s_cmp_lt_i32 s55, -34
    s_cselect_b32 s56, 1, s56
    v_mov_b32 v6, s56
    ds_write_b32 v1, v6 offset:316
L_bal_next:
    s_cmp_lt_u32 s49, 24
    s_cbranch_scc1 L_bal
L_bal_end:
    s_endpgm
.section .rodata,"a"
.p2align 6
.amdhsa_kernel recurrent_scan__mha_block_cached__glu_gated_glu__decode_kernel
  .amdhsa_next_free_vgpr 244
  .amdhsa_next_free_sgpr 102
  .amdhsa_accum_offset 244
  .amdhsa_group_segment_fixed_size 0
  .amdhsa_kernarg_size 96
  .amdhsa_user_sgpr_count 2
  .amdhsa_user_sgpr_kernarg_segment_ptr 1
  .amdhsa_system_sgpr_workgroup_id_x 1
.end_amdhsa_kernel
```
